```python
import torch

def _softmax(x, axis=-1):
    return torch.softmax(x, dim=axis)
def _gelu(x):
    return torch.nn.functional.gelu(x, approximate="tanh")
def _silu(x):
    return torch.nn.functional.silu(x)
def _sigmoid(x):
    return torch.sigmoid(x)
def _layernorm(x, axis=-1, eps=1e-5):
    m = x.mean(dim=axis, keepdim=True)
    v = x.var(dim=axis, keepdim=True, unbiased=False)
    return (x - m) / torch.sqrt(v + eps)
def _scatter_add(tgt, idx, src, axis=0):
    return tgt.clone().index_add_(axis, idx, src)
def _segment_sum(src, seg, n):
    out = torch.zeros((n,) + src.shape[1:], dtype=src.dtype)
    return out.index_add_(0, seg, src)
def _pad(x, pw):
    flat = tuple(v for pair in reversed(pw) for v in pair)
    return torch.nn.functional.pad(x, flat)

kernel_name = 'sequential_preLN__ssm_conv_s4d__glu_gated_geglu__prompt'

def setup_inputs():

    _w = (lambda a: (lambda t: t.to(torch.bfloat16) if t.is_floating_point() else t)(torch.as_tensor(a)))
    def _A_setup():
        Bsz, L, D, N = 1, 2048, 640, 128
        return {
            "u": _w((lambda *s: torch.randn(*s, dtype=torch.bfloat16) * 0.05)(Bsz, L, D)),
            "log_A_real": _w((lambda *s: torch.randn(*s, dtype=torch.bfloat16) * 6.4)(D, N) * 0.5),
            "A_imag": _w((lambda *s: torch.randn(*s, dtype=torch.bfloat16) * 0.05)(D, N) * 3.14),
            "C_real": _w((lambda *s: torch.randn(*s, dtype=torch.bfloat16) * 0.05)(D, N) / N ** 0.5),
            "C_imag": _w((lambda *s: torch.randn(*s, dtype=torch.bfloat16) * 0.05)(D, N) / N ** 0.5),
            "log_dt": _w((lambda *s: torch.randn(*s, dtype=torch.bfloat16) * 0.05)(D) * 0.5 - 4.0),
            "D_skip": _w((lambda *s: torch.randn(*s, dtype=torch.bfloat16) * 0.05)(D)),
        }
    _A_in = _A_setup()

    def _B_setup():
        B, S, Dm, Df = 1, 2048, 640, 1728
        return {
            "x": _w((lambda *s: torch.randn(*s, dtype=torch.bfloat16) * 0.05)(B, S, Dm)),
            "w_gate": _w((lambda *s: torch.randn(*s, dtype=torch.bfloat16) * 0.4)(Dm, Df) * (Dm ** -0.5)),
            "w_up": _w((lambda *s: torch.randn(*s, dtype=torch.bfloat16) * 0.4)(Dm, Df) * (Dm ** -0.5)),
            "w_down": _w((lambda *s: torch.randn(*s, dtype=torch.bfloat16) * 0.4)(Df, Dm) * (Df ** -0.5)),
        }
    _B_in = _B_setup()

    return {
        "A_u": _A_in["u"],
        "A_log_A_real": _A_in["log_A_real"],
        "A_A_imag": _A_in["A_imag"],
        "A_C_real": _A_in["C_real"],
        "A_C_imag": _A_in["C_imag"],
        "A_log_dt": _A_in["log_dt"],
        "A_D_skip": _A_in["D_skip"],
        "B_x": _B_in["x"],
        "B_w_gate": _B_in["w_gate"],
        "B_w_up": _B_in["w_up"],
        "B_w_down": _B_in["w_down"],
    }

def reference(A_u, A_log_A_real, A_A_imag, A_C_real, A_C_imag, A_log_dt, A_D_skip, B_x, B_w_gate, B_w_up, B_w_down):
    def _A_ref(u, log_A_real, A_imag, C_real, C_imag, log_dt, D_skip):
        L = u.shape[1]
        dt = torch.exp(log_dt)
        A = -torch.exp(log_A_real) + 1j * A_imag
        C = (C_real + 1j * C_imag) * dt[:, None]
        pos = (lambda x, dt: x.to(dt))(torch.arange(L), log_dt.dtype)
        P = torch.exp((A * dt[:, None])[:, :, None] * pos[None, None, :])
        K = 2.0 * torch.einsum("dn,dnl->dl", C, P).real
        L2 = 2 * L
        u_t = (lambda x, *d: x.permute(*d))(u, 0, 2, 1)
        Kf = (lambda x, *a, **k: torch.fft.rfft(x.float(), *a, **k))(K, L2)
        Uf = (lambda x, *a, **k: torch.fft.rfft(x.float(), *a, **k))(u_t, L2)
        y = (lambda x, *a, **k: torch.fft.irfft(x, *a, **k).to(torch.bfloat16))(Uf * Kf[None, :, :], L2)[:, :, :L]
        y = (lambda x, *d: x.permute(*d))(y, 0, 2, 1)
        return y + u * D_skip[None, None, :]

    def _B_ref(x, w_gate, w_up, w_down):
        g = torch.einsum("bsd,df->bsf", x, w_gate)
        u = torch.einsum("bsd,df->bsf", x, w_up)
        h = _gelu(g) * u
        return torch.einsum("bsf,fd->bsd", h, w_down)

    x = A_u
    h = x + _A_ref(_layernorm(x, axis=-1), A_log_A_real, A_A_imag, A_C_real, A_C_imag, A_log_dt, A_D_skip)
    h2 = h + _B_ref(_layernorm(h, axis=-1), B_w_gate, B_w_up, B_w_down)
    return h2
```

```asm
; @launch kernel=prep_kernel grid=(758,1,1) block=(256,1,1) lds=51200
; @launch kernel=conv_kernel grid=(640,1,1) block=(192,1,1) lds=47616
; @launch kernel=gemm1_kernel grid=(464,1,1) block=(256,1,1) lds=65536
; @launch kernel=gemm2_kernel grid=(160,1,1) block=(256,1,1) lds=147456
.amdgcn_target "amdgcn-amd-amdhsa--gfx950"
.text
.globl prep_kernel
.p2align 8
.type prep_kernel,@function
prep_kernel:
    s_cmp_ge_u32 s2, 758
    s_cbranch_scc1 prep_kernel_end
    s_load_dwordx2 s[4:5], s[0:1], 0
    s_load_dwordx2 s[8:9], s[0:1], 104
    s_load_dwordx2 s[20:21], s[0:1], 8
    s_load_dwordx2 s[24:25], s[0:1], 16
    s_load_dwordx2 s[28:29], s[0:1], 24
    s_load_dwordx2 s[32:33], s[0:1], 32
    s_load_dwordx2 s[36:37], s[0:1], 40
    s_load_dwordx2 s[44:45], s[0:1], 64
    s_load_dwordx2 s[48:49], s[0:1], 72
    s_load_dwordx2 s[52:53], s[0:1], 80
    s_waitcnt lgkmcnt(0)
    s_and_b32 s5, s5, 0xffff
    s_mov_b32 s6, 2621440
    s_mov_b32 s7, 0x00020000
    s_and_b32 s9, s9, 0xffff
    s_mov_b32 s10, 268435456
    s_mov_b32 s11, 0x00020000
    s_and_b32 s21, s21, 0xffff
    s_mov_b32 s22, 163840
    s_mov_b32 s23, 0x00020000
    s_and_b32 s25, s25, 0xffff
    s_mov_b32 s26, 163840
    s_mov_b32 s27, 0x00020000
    s_and_b32 s29, s29, 0xffff
    s_mov_b32 s30, 163840
    s_mov_b32 s31, 0x00020000
    s_and_b32 s33, s33, 0xffff
    s_mov_b32 s34, 163840
    s_mov_b32 s35, 0x00020000
    s_and_b32 s37, s37, 0xffff
    s_mov_b32 s38, 1280
    s_mov_b32 s39, 0x00020000
    s_and_b32 s45, s45, 0xffff
    s_mov_b32 s46, 2211840
    s_mov_b32 s47, 0x00020000
    s_and_b32 s49, s49, 0xffff
    s_mov_b32 s50, 2211840
    s_mov_b32 s51, 0x00020000
    s_and_b32 s53, s53, 0xffff
    s_mov_b32 s54, 2211840
    s_mov_b32 s55, 0x00020000
    s_cmp_lt_u32 s2, 64
    s_cbranch_scc1 prep_kernel_ln1
    s_sub_u32 s56, s2, 64
    s_cmp_lt_u32 s56, 54
    s_cbranch_scc1 prep_kernel_cs
    s_sub_u32 s56, s56, 54
    s_cmp_lt_u32 s56, 0
    s_cbranch_scc1 prep_kernel_to
    s_sub_u32 s56, s56, 0
    v_and_b32 v1, 63, v0
    v_lshrrev_b32 v2, 6, v0
    v_and_b32 v3, 31, v1
    v_lshrrev_b32 v4, 5, v1
    s_lshl_b32 s12, s56, 8
    v_lshl_add_u32 v5, v2, 5, v3
    v_lshlrev_b32 v5, 1, v5
    v_add_u32 v5, s12, v5
    buffer_load_ushort v8, v5, s[20:23], 0 offen
    buffer_load_ushort v9, v5, s[24:27], 0 offen
    buffer_load_ushort v10, v5, s[28:31], 0 offen
    buffer_load_ushort v11, v5, s[32:35], 0 offen
    s_lshl_b32 s12, s56, 1
    v_mov_b32 v6, s12
    buffer_load_ushort v12, v6, s[36:39], 0 offen
    v_mul_u32_u24 v20, 6912, v2
    v_lshl_add_u32 v21, v3, 2, v20
    v_mul_u32_u24 v23, 1584, v4
    v_add_u32 v21, v21, v23
    v_cvt_f32_u32 v22, v4
    v_lshlrev_b32 v29, 3, v3
    v_cvt_f32_u32 v29, v29
    v_lshlrev_b32 v28, 4, v4
    s_mov_b32 s41, 0xffff0000
    s_mov_b32 s42, 0x3fb8aa3b
    s_waitcnt vmcnt(0)
    v_lshlrev_b32 v8, 16, v8
    v_lshlrev_b32 v9, 16, v9
    v_lshlrev_b32 v10, 16, v10
    v_lshlrev_b32 v11, 16, v11
    v_lshlrev_b32 v12, 16, v12
    v_mul_f32 v12, s42, v12
    v_mul_f32 v8, s42, v8
    v_exp_f32 v12, v12
    v_exp_f32 v8, v8
    s_nop 0
    v_cvt_pk_bf16_f32 v12, v12, v8
    v_and_b32 v8, s41, v12
    v_lshlrev_b32 v12, 16, v12
    v_mul_f32 v8, v8, v12
    v_mul_f32 v8, s42, v8
    v_sub_f32 v8, 0, v8
    v_mul_f32 v9, v9, v12
    v_mul_f32 v9, 0x3e22f983, v9
    v_mul_f32 v10, v10, v12
    v_mul_f32 v11, v11, v12
    v_add_f32 v10, v10, v10
    v_add_f32 v11, v11, v11
    ds_bpermute_b32 v80, v28, v8 offset:0
    ds_bpermute_b32 v81, v28, v9 offset:0
    ds_bpermute_b32 v82, v28, v8 offset:4
    ds_bpermute_b32 v83, v28, v9 offset:4
    ds_bpermute_b32 v84, v28, v8 offset:8
    ds_bpermute_b32 v85, v28, v9 offset:8
    ds_bpermute_b32 v86, v28, v8 offset:12
    ds_bpermute_b32 v87, v28, v9 offset:12
    ds_bpermute_b32 v88, v28, v8 offset:32
    ds_bpermute_b32 v89, v28, v9 offset:32
    ds_bpermute_b32 v90, v28, v8 offset:36
    ds_bpermute_b32 v91, v28, v9 offset:36
    ds_bpermute_b32 v92, v28, v8 offset:40
    ds_bpermute_b32 v93, v28, v9 offset:40
    ds_bpermute_b32 v94, v28, v8 offset:44
    ds_bpermute_b32 v95, v28, v9 offset:44
    ds_bpermute_b32 v96, v28, v8 offset:64
    ds_bpermute_b32 v97, v28, v9 offset:64
    ds_bpermute_b32 v98, v28, v8 offset:68
    ds_bpermute_b32 v99, v28, v9 offset:68
    ds_bpermute_b32 v100, v28, v8 offset:72
    ds_bpermute_b32 v101, v28, v9 offset:72
    ds_bpermute_b32 v102, v28, v8 offset:76
    ds_bpermute_b32 v103, v28, v9 offset:76
    ds_bpermute_b32 v104, v28, v8 offset:96
    ds_bpermute_b32 v105, v28, v9 offset:96
    ds_bpermute_b32 v106, v28, v8 offset:100
    ds_bpermute_b32 v107, v28, v9 offset:100
    ds_bpermute_b32 v108, v28, v8 offset:104
    ds_bpermute_b32 v109, v28, v9 offset:104
    ds_bpermute_b32 v110, v28, v8 offset:108
    ds_bpermute_b32 v111, v28, v9 offset:108
    v_mov_b32 v30, 0x00000000
    v_fmamk_f32 v30, v22, 0x43830000, v30
    v_mul_f32 v31, v8, v30
    v_mul_f32 v32, v9, v30
    v_exp_f32 v31, v31
    v_fract_f32 v32, v32
    s_nop 0
    v_cos_f32 v33, v32
    v_sin_f32 v34, v32
    s_nop 0
    v_mul_f32 v36, v10, v33
    v_mul_f32 v37, v10, v34
    v_fma_f32 v36, -v11, v34, v36
    v_fma_f32 v37, v11, v33, v37
    v_mul_f32 v36, v36, v31
    v_mul_f32 v37, v37, -v31
    v_cvt_pk_bf16_f32 v38, v36, v37
    v_lshlrev_b32 v39, 16, v38
    v_and_b32 v40, s41, v38
    v_sub_f32 v36, v36, v39
    v_sub_f32 v37, v37, v40
    v_cvt_pk_bf16_f32 v39, v36, v37
    ds_write_b32 v21, v38 offset:0
    ds_write_b32 v21, v39 offset:3456
    v_mov_b32 v30, 0x3f800000
    v_fmamk_f32 v30, v22, 0x43ff8000, v30
    v_mul_f32 v31, v8, v30
    v_mul_f32 v32, v9, v30
    v_exp_f32 v31, v31
    v_fract_f32 v32, v32
    s_nop 0
    v_cos_f32 v33, v32
    v_sin_f32 v34, v32
    s_nop 0
    v_mul_f32 v36, v10, v33
    v_mul_f32 v37, v10, v34
    v_fma_f32 v36, -v11, v34, v36
    v_fma_f32 v37, v11, v33, v37
    v_mul_f32 v36, v36, v31
    v_mul_f32 v37, v37, -v31
    v_cvt_pk_bf16_f32 v38, v36, v37
    v_lshlrev_b32 v39, 16, v38
    v_and_b32 v40, s41, v38
    v_sub_f32 v36, v36, v39
    v_sub_f32 v37, v37, v40
    v_cvt_pk_bf16_f32 v39, v36, v37
    ds_write_b32 v21, v38 offset:144
    ds_write_b32 v21, v39 offset:3600
    v_mov_b32 v30, 0x40000000
    v_fmamk_f32 v30, v22, 0x44008000, v30
    v_mul_f32 v31, v8, v30
    v_mul_f32 v32, v9, v30
    v_exp_f32 v31, v31
    v_fract_f32 v32, v32
    s_nop 0
    v_cos_f32 v33, v32
    v_sin_f32 v34, v32
    s_nop 0
    v_mul_f32 v36, v10, v33
    v_mul_f32 v37, v10, v34
    v_fma_f32 v36, -v11, v34, v36
    v_fma_f32 v37, v11, v33, v37
    v_mul_f32 v36, v36, v31
    v_mul_f32 v37, v37, -v31
    v_cvt_pk_bf16_f32 v38, v36, v37
    v_lshlrev_b32 v39, 16, v38
    v_and_b32 v40, s41, v38
    v_sub_f32 v36, v36, v39
    v_sub_f32 v37, v37, v40
    v_cvt_pk_bf16_f32 v39, v36, v37
    ds_write_b32 v21, v38 offset:288
    ds_write_b32 v21, v39 offset:3744
    v_mov_b32 v30, 0x40400000
    v_fmamk_f32 v30, v22, 0x443f4000, v30
    v_mul_f32 v31, v8, v30
    v_mul_f32 v32, v9, v30
    v_exp_f32 v31, v31
    v_fract_f32 v32, v32
    s_nop 0
    v_cos_f32 v33, v32
    v_sin_f32 v34, v32
    s_nop 0
    v_mul_f32 v36, v10, v33
    v_mul_f32 v37, v10, v34
    v_fma_f32 v36, -v11, v34, v36
    v_fma_f32 v37, v11, v33, v37
    v_mul_f32 v36, v36, v31
    v_mul_f32 v37, v37, -v31
    v_cvt_pk_bf16_f32 v38, v36, v37
    v_lshlrev_b32 v39, 16, v38
    v_and_b32 v40, s41, v38
    v_sub_f32 v36, v36, v39
    v_sub_f32 v37, v37, v40
    v_cvt_pk_bf16_f32 v39, v36, v37
    ds_write_b32 v21, v38 offset:432
    ds_write_b32 v21, v39 offset:3888
    v_mov_b32 v30, 0x40800000
    v_fmamk_f32 v30, v22, 0x44400000, v30
    v_mul_f32 v31, v8, v30
    v_mul_f32 v32, v9, v30
    v_exp_f32 v31, v31
    v_fract_f32 v32, v32
    s_nop 0
    v_cos_f32 v33, v32
    v_sin_f32 v34, v32
    s_nop 0
    v_mul_f32 v36, v10, v33
    v_mul_f32 v37, v10, v34
    v_fma_f32 v36, -v11, v34, v36
    v_fma_f32 v37, v11, v33, v37
    v_mul_f32 v36, v36, v31
    v_mul_f32 v37, v37, -v31
    v_cvt_pk_bf16_f32 v38, v36, v37
    v_lshlrev_b32 v39, 16, v38
    v_and_b32 v40, s41, v38
    v_sub_f32 v36, v36, v39
    v_sub_f32 v37, v37, v40
    v_cvt_pk_bf16_f32 v39, v36, v37
    ds_write_b32 v21, v38 offset:576
    ds_write_b32 v21, v39 offset:4032
    v_mov_b32 v30, 0x40a00000
    v_fmamk_f32 v30, v22, 0x447ec000, v30
    v_mul_f32 v31, v8, v30
    v_mul_f32 v32, v9, v30
    v_exp_f32 v31, v31
    v_fract_f32 v32, v32
    s_nop 0
    v_cos_f32 v33, v32
    v_sin_f32 v34, v32
    s_nop 0
    v_mul_f32 v36, v10, v33
    v_mul_f32 v37, v10, v34
    v_fma_f32 v36, -v11, v34, v36
    v_fma_f32 v37, v11, v33, v37
    v_mul_f32 v36, v36, v31
    v_mul_f32 v37, v37, -v31
    v_cvt_pk_bf16_f32 v38, v36, v37
    v_lshlrev_b32 v39, 16, v38
    v_and_b32 v40, s41, v38
    v_sub_f32 v36, v36, v39
    v_sub_f32 v37, v37, v40
    v_cvt_pk_bf16_f32 v39, v36, v37
    ds_write_b32 v21, v38 offset:720
    ds_write_b32 v21, v39 offset:4176
    v_mov_b32 v30, 0x40c00000
    v_fmamk_f32 v30, v22, 0x449f4000, v30
    v_mul_f32 v31, v8, v30
    v_mul_f32 v32, v9, v30
    v_exp_f32 v31, v31
    v_fract_f32 v32, v32
    s_nop 0
    v_cos_f32 v33, v32
    v_sin_f32 v34, v32
    s_nop 0
    v_mul_f32 v36, v10, v33
    v_mul_f32 v37, v10, v34
    v_fma_f32 v36, -v11, v34, v36
    v_fma_f32 v37, v11, v33, v37
    v_mul_f32 v36, v36, v31
    v_mul_f32 v37, v37, -v31
    v_cvt_pk_bf16_f32 v38, v36, v37
    v_lshlrev_b32 v39, 16, v38
    v_and_b32 v40, s41, v38
    v_sub_f32 v36, v36, v39
    v_sub_f32 v37, v37, v40
    v_cvt_pk_bf16_f32 v39, v36, v37
    ds_write_b32 v21, v38 offset:864
    ds_write_b32 v21, v39 offset:4320
    v_mov_b32 v30, 0x40e00000
    v_fmamk_f32 v30, v22, 0x44bf2000, v30
    v_mul_f32 v31, v8, v30
    v_mul_f32 v32, v9, v30
    v_exp_f32 v31, v31
    v_fract_f32 v32, v32
    s_nop 0
    v_cos_f32 v33, v32
    v_sin_f32 v34, v32
    s_nop 0
    v_mul_f32 v36, v10, v33
    v_mul_f32 v37, v10, v34
    v_fma_f32 v36, -v11, v34, v36
    v_fma_f32 v37, v11, v33, v37
    v_mul_f32 v36, v36, v31
    v_mul_f32 v37, v37, -v31
    v_cvt_pk_bf16_f32 v38, v36, v37
    v_lshlrev_b32 v39, 16, v38
    v_and_b32 v40, s41, v38
    v_sub_f32 v36, v36, v39
    v_sub_f32 v37, v37, v40
    v_cvt_pk_bf16_f32 v39, v36, v37
    ds_write_b32 v21, v38 offset:1008
    ds_write_b32 v21, v39 offset:4464
    v_mov_b32 v30, 0x43800000
    v_fmamk_f32 v30, v22, 0x44c00000, v30
    v_mul_f32 v31, v8, v30
    v_mul_f32 v32, v9, v30
    v_exp_f32 v31, v31
    v_fract_f32 v32, v32
    s_nop 0
    v_cos_f32 v33, v32
    v_sin_f32 v34, v32
    s_nop 0
    v_mul_f32 v36, v10, v33
    v_mul_f32 v37, v10, v34
    v_fma_f32 v36, -v11, v34, v36
    v_fma_f32 v37, v11, v33, v37
    v_mul_f32 v36, v36, v31
    v_mul_f32 v37, v37, -v31
    v_cvt_pk_bf16_f32 v38, v36, v37
    v_lshlrev_b32 v39, 16, v38
    v_and_b32 v40, s41, v38
    v_sub_f32 v36, v36, v39
    v_sub_f32 v37, v37, v40
    v_cvt_pk_bf16_f32 v39, v36, v37
    ds_write_b32 v21, v38 offset:1152
    ds_write_b32 v21, v39 offset:4608
    v_mov_b32 v30, 0x43810000
    v_fmamk_f32 v30, v22, 0x44dfc000, v30
    v_mul_f32 v31, v8, v30
    v_mul_f32 v32, v9, v30
    v_exp_f32 v31, v31
    v_fract_f32 v32, v32
    s_nop 0
    v_cos_f32 v33, v32
    v_sin_f32 v34, v32
    s_nop 0
    v_mul_f32 v36, v10, v33
    v_mul_f32 v37, v10, v34
    v_fma_f32 v36, -v11, v34, v36
    v_fma_f32 v37, v11, v33, v37
    v_mul_f32 v36, v36, v31
    v_mul_f32 v37, v37, -v31
    v_cvt_pk_bf16_f32 v38, v36, v37
    v_lshlrev_b32 v39, 16, v38
    v_and_b32 v40, s41, v38
    v_sub_f32 v36, v36, v39
    v_sub_f32 v37, v37, v40
    v_cvt_pk_bf16_f32 v39, v36, v37
    ds_write_b32 v21, v38 offset:1296
    ds_write_b32 v21, v39 offset:4752
    v_mov_b32 v30, 0x43820000
    v_fmamk_f32 v30, v22, 0x44df8000, v30
    v_mul_f32 v31, v8, v30
    v_mul_f32 v32, v9, v30
    v_exp_f32 v31, v31
    v_fract_f32 v32, v32
    s_nop 0
    v_cos_f32 v33, v32
    v_sin_f32 v34, v32
    s_nop 0
    v_mul_f32 v36, v10, v33
    v_mul_f32 v37, v10, v34
    v_fma_f32 v36, -v11, v34, v36
    v_fma_f32 v37, v11, v33, v37
    v_mul_f32 v36, v36, v31
    v_mul_f32 v37, v37, -v31
    v_cvt_pk_bf16_f32 v38, v36, v37
    v_lshlrev_b32 v39, 16, v38
    v_and_b32 v40, s41, v38
    v_sub_f32 v36, v36, v39
    v_sub_f32 v37, v37, v40
    v_cvt_pk_bf16_f32 v39, v36, v37
    ds_write_b32 v21, v38 offset:1440
    ds_write_b32 v21, v39 offset:4896
    s_waitcnt lgkmcnt(0)
    v_mul_u32_u24 v47, 144, v3
    v_min_u32 v47, 3312, v47
    v_lshl_add_u32 v47, v4, 4, v47
    v_add_u32 v47, v47, v20
    v_mov_b32 v64, 0
    v_mov_b32 v65, 0
    v_mov_b32 v66, 0
    v_mov_b32 v67, 0
    v_mov_b32 v68, 0
    v_mov_b32 v69, 0
    v_mov_b32 v70, 0
    v_mov_b32 v71, 0
    v_mov_b32 v72, 0
    v_mov_b32 v73, 0
    v_mov_b32 v74, 0
    v_mov_b32 v75, 0
    v_mov_b32 v76, 0
    v_mov_b32 v77, 0
    v_mov_b32 v78, 0
    v_mov_b32 v79, 0
    ds_read_b128 v[112:115], v47 offset:0
    ds_read_b128 v[116:119], v47 offset:3456
    v_mul_f32 v31, v80, v29
    v_mul_f32 v32, v81, v29
    v_mul_f32 v35, v82, v29
    v_mul_f32 v36, v83, v29
    v_mul_f32 v39, v84, v29
    v_mul_f32 v40, v85, v29
    v_mul_f32 v43, v86, v29
    v_mul_f32 v44, v87, v29
    v_exp_f32 v31, v31
    v_fract_f32 v32, v32
    v_exp_f32 v35, v35
    v_fract_f32 v36, v36
    v_exp_f32 v39, v39
    v_fract_f32 v40, v40
    v_exp_f32 v43, v43
    v_fract_f32 v44, v44
    v_cos_f32 v33, v32
    v_sin_f32 v34, v32
    v_cos_f32 v37, v36
    v_sin_f32 v38, v36
    v_cos_f32 v41, v40
    v_sin_f32 v42, v40
    v_cos_f32 v45, v44
    v_sin_f32 v30, v44
    s_nop 0
    v_mul_f32 v33, v33, v31
    v_mul_f32 v34, v34, v31
    v_cvt_pk_bf16_f32 v48, v33, v34
    v_mul_f32 v37, v37, v35
    v_mul_f32 v38, v38, v35
    v_cvt_pk_bf16_f32 v49, v37, v38
    v_mul_f32 v41, v41, v39
    v_mul_f32 v42, v42, v39
    v_cvt_pk_bf16_f32 v50, v41, v42
    v_mul_f32 v45, v45, v43
    v_mul_f32 v30, v30, v43
    v_cvt_pk_bf16_f32 v51, v45, v30
    s_waitcnt lgkmcnt(0)
    s_nop 0
    v_mfma_f32_32x32x16_bf16 v[64:79], v[112:115], v[48:51], v[64:79]
    v_mfma_f32_32x32x16_bf16 v[64:79], v[116:119], v[48:51], v[64:79]
    ds_read_b128 v[120:123], v47 offset:32
    ds_read_b128 v[124:127], v47 offset:3488
    v_mul_f32 v31, v88, v29
    v_mul_f32 v32, v89, v29
    v_mul_f32 v35, v90, v29
    v_mul_f32 v36, v91, v29
    v_mul_f32 v39, v92, v29
    v_mul_f32 v40, v93, v29
    v_mul_f32 v43, v94, v29
    v_mul_f32 v44, v95, v29
    v_exp_f32 v31, v31
    v_fract_f32 v32, v32
    v_exp_f32 v35, v35
    v_fract_f32 v36, v36
    v_exp_f32 v39, v39
    v_fract_f32 v40, v40
    v_exp_f32 v43, v43
    v_fract_f32 v44, v44
    v_cos_f32 v33, v32
    v_sin_f32 v34, v32
    v_cos_f32 v37, v36
    v_sin_f32 v38, v36
    v_cos_f32 v41, v40
    v_sin_f32 v42, v40
    v_cos_f32 v45, v44
    v_sin_f32 v30, v44
    s_nop 0
    v_mul_f32 v33, v33, v31
    v_mul_f32 v34, v34, v31
    v_cvt_pk_bf16_f32 v52, v33, v34
    v_mul_f32 v37, v37, v35
    v_mul_f32 v38, v38, v35
    v_cvt_pk_bf16_f32 v53, v37, v38
    v_mul_f32 v41, v41, v39
    v_mul_f32 v42, v42, v39
    v_cvt_pk_bf16_f32 v54, v41, v42
    v_mul_f32 v45, v45, v43
    v_mul_f32 v30, v30, v43
    v_cvt_pk_bf16_f32 v55, v45, v30
    s_waitcnt lgkmcnt(0)
    s_nop 0
    v_mfma_f32_32x32x16_bf16 v[64:79], v[120:123], v[52:55], v[64:79]
    v_mfma_f32_32x32x16_bf16 v[64:79], v[124:127], v[52:55], v[64:79]
    ds_read_b128 v[112:115], v47 offset:64
    ds_read_b128 v[116:119], v47 offset:3520
    v_mul_f32 v31, v96, v29
    v_mul_f32 v32, v97, v29
    v_mul_f32 v35, v98, v29
    v_mul_f32 v36, v99, v29
    v_mul_f32 v39, v100, v29
    v_mul_f32 v40, v101, v29
    v_mul_f32 v43, v102, v29
    v_mul_f32 v44, v103, v29
    v_exp_f32 v31, v31
    v_fract_f32 v32, v32
    v_exp_f32 v35, v35
    v_fract_f32 v36, v36
    v_exp_f32 v39, v39
    v_fract_f32 v40, v40
    v_exp_f32 v43, v43
    v_fract_f32 v44, v44
    v_cos_f32 v33, v32
    v_sin_f32 v34, v32
    v_cos_f32 v37, v36
    v_sin_f32 v38, v36
    v_cos_f32 v41, v40
    v_sin_f32 v42, v40
    v_cos_f32 v45, v44
    v_sin_f32 v30, v44
    s_nop 0
    v_mul_f32 v33, v33, v31
    v_mul_f32 v34, v34, v31
    v_cvt_pk_bf16_f32 v48, v33, v34
    v_mul_f32 v37, v37, v35
    v_mul_f32 v38, v38, v35
    v_cvt_pk_bf16_f32 v49, v37, v38
    v_mul_f32 v41, v41, v39
    v_mul_f32 v42, v42, v39
    v_cvt_pk_bf16_f32 v50, v41, v42
    v_mul_f32 v45, v45, v43
    v_mul_f32 v30, v30, v43
    v_cvt_pk_bf16_f32 v51, v45, v30
    s_waitcnt lgkmcnt(0)
    s_nop 0
    v_mfma_f32_32x32x16_bf16 v[64:79], v[112:115], v[48:51], v[64:79]
    v_mfma_f32_32x32x16_bf16 v[64:79], v[116:119], v[48:51], v[64:79]
    ds_read_b128 v[120:123], v47 offset:96
    ds_read_b128 v[124:127], v47 offset:3552
    v_mul_f32 v31, v104, v29
    v_mul_f32 v32, v105, v29
    v_mul_f32 v35, v106, v29
    v_mul_f32 v36, v107, v29
    v_mul_f32 v39, v108, v29
    v_mul_f32 v40, v109, v29
    v_mul_f32 v43, v110, v29
    v_mul_f32 v44, v111, v29
    v_exp_f32 v31, v31
    v_fract_f32 v32, v32
    v_exp_f32 v35, v35
    v_fract_f32 v36, v36
    v_exp_f32 v39, v39
    v_fract_f32 v40, v40
    v_exp_f32 v43, v43
    v_fract_f32 v44, v44
    v_cos_f32 v33, v32
    v_sin_f32 v34, v32
    v_cos_f32 v37, v36
    v_sin_f32 v38, v36
    v_cos_f32 v41, v40
    v_sin_f32 v42, v40
    v_cos_f32 v45, v44
    v_sin_f32 v30, v44
    s_nop 0
    v_mul_f32 v33, v33, v31
    v_mul_f32 v34, v34, v31
    v_cvt_pk_bf16_f32 v52, v33, v34
    v_mul_f32 v37, v37, v35
    v_mul_f32 v38, v38, v35
    v_cvt_pk_bf16_f32 v53, v37, v38
    v_mul_f32 v41, v41, v39
    v_mul_f32 v42, v42, v39
    v_cvt_pk_bf16_f32 v54, v41, v42
    v_mul_f32 v45, v45, v43
    v_mul_f32 v30, v30, v43
    v_cvt_pk_bf16_f32 v55, v45, v30
    s_waitcnt lgkmcnt(0)
    s_nop 0
    v_mfma_f32_32x32x16_bf16 v[64:79], v[120:123], v[52:55], v[64:79]
    v_mfma_f32_32x32x16_bf16 v[64:79], v[124:127], v[52:55], v[64:79]
    v_lshlrev_b32 v42, 9, v4
    v_lshl_add_u32 v42, v3, 2, v42
    v_add_u32 v42, v42, v20
    s_nop 7
    s_nop 3
    ds_write_b32 v42, v64 offset:0
    ds_write_b32 v42, v65 offset:128
    ds_write_b32 v42, v66 offset:256
    ds_write_b32 v42, v67 offset:384
    ds_write_b32 v42, v68 offset:1024
    ds_write_b32 v42, v69 offset:1152
    ds_write_b32 v42, v70 offset:1280
    ds_write_b32 v42, v71 offset:1408
    ds_write_b32 v42, v72 offset:2048
    ds_write_b32 v42, v73 offset:2176
    ds_write_b32 v42, v74 offset:2304
    ds_write_b32 v42, v75 offset:2432
    s_waitcnt lgkmcnt(0)
    s_barrier
    v_add_u32 v43, 0, v0
    v_lshlrev_b32 v44, 2, v43
    ds_read_b32 v45, v44 offset:0
    ds_read_b32 v46, v44 offset:6912
    ds_read_b32 v47, v44 offset:13824
    ds_read_b32 v48, v44 offset:20736
    v_lshrrev_b32 v50, 5, v43
    v_and_b32 v51, 31, v43
    v_mov_b32 v52, v50
    v_subrev_u32 v53, 8, v50
    v_lshlrev_b32 v53, 1, v53
    v_add_u32 v53, 0x100, v53
    v_cmp_le_u32 vcc, 8, v50
    v_subrev_u32 v54, 12, v50
    v_and_b32 v55, 1, v54
    v_cndmask_b32 v52, v52, v53, vcc
    v_lshlrev_b32 v55, 2, v55
    v_lshrrev_b32 v54, 1, v54
    v_lshl_add_u32 v54, v54, 8, v55
    v_add_u32 v54, 0x200, v54
    v_cmp_le_u32 vcc, 12, v50
    v_subrev_u32 v53, 16, v50
    v_lshlrev_b32 v53, 8, v53
    v_cndmask_b32 v52, v52, v54, vcc
    v_add_u32 v53, 0x400, v53
    v_cmp_le_u32 vcc, 16, v50
    s_nop 1
    v_cndmask_b32 v52, v52, v53, vcc
    v_lshl_add_u32 v52, v51, 3, v52
    v_min_u32 v52, 0x801, v52
    v_cmp_gt_u32 vcc, 0x2a0, v43
    v_mov_b32 v53, 0x801
    s_nop 0
    v_cndmask_b32 v52, v53, v52, vcc
    v_lshlrev_b32 v52, 2, v52
    s_waitcnt lgkmcnt(0)
    v_add_f32 v45, v45, v46
    v_add_f32 v47, v47, v48
    v_add_f32 v45, v45, v47
    ds_write_b32 v52, v45 offset:27648
    v_add_u32 v43, 256, v0
    v_lshlrev_b32 v44, 2, v43
    ds_read_b32 v45, v44 offset:0
    ds_read_b32 v46, v44 offset:6912
    ds_read_b32 v47, v44 offset:13824
    ds_read_b32 v48, v44 offset:20736
    v_lshrrev_b32 v50, 5, v43
    v_and_b32 v51, 31, v43
    v_mov_b32 v52, v50
    v_subrev_u32 v53, 8, v50
    v_lshlrev_b32 v53, 1, v53
    v_add_u32 v53, 0x100, v53
    v_cmp_le_u32 vcc, 8, v50
    v_subrev_u32 v54, 12, v50
    v_and_b32 v55, 1, v54
    v_cndmask_b32 v52, v52, v53, vcc
    v_lshlrev_b32 v55, 2, v55
    v_lshrrev_b32 v54, 1, v54
    v_lshl_add_u32 v54, v54, 8, v55
    v_add_u32 v54, 0x200, v54
    v_cmp_le_u32 vcc, 12, v50
    v_subrev_u32 v53, 16, v50
    v_lshlrev_b32 v53, 8, v53
    v_cndmask_b32 v52, v52, v54, vcc
    v_add_u32 v53, 0x400, v53
    v_cmp_le_u32 vcc, 16, v50
    s_nop 1
    v_cndmask_b32 v52, v52, v53, vcc
    v_lshl_add_u32 v52, v51, 3, v52
    v_min_u32 v52, 0x801, v52
    v_cmp_gt_u32 vcc, 0x2a0, v43
    v_mov_b32 v53, 0x801
    s_nop 0
    v_cndmask_b32 v52, v53, v52, vcc
    v_lshlrev_b32 v52, 2, v52
    s_waitcnt lgkmcnt(0)
    v_add_f32 v45, v45, v46
    v_add_f32 v47, v47, v48
    v_add_f32 v45, v45, v47
    ds_write_b32 v52, v45 offset:27648
    v_add_u32 v43, 512, v0
    v_lshlrev_b32 v44, 2, v43
    ds_read_b32 v45, v44 offset:0
    ds_read_b32 v46, v44 offset:6912
    ds_read_b32 v47, v44 offset:13824
    ds_read_b32 v48, v44 offset:20736
    v_lshrrev_b32 v50, 5, v43
    v_and_b32 v51, 31, v43
    v_mov_b32 v52, v50
    v_subrev_u32 v53, 8, v50
    v_lshlrev_b32 v53, 1, v53
    v_add_u32 v53, 0x100, v53
    v_cmp_le_u32 vcc, 8, v50
    v_subrev_u32 v54, 12, v50
    v_and_b32 v55, 1, v54
    v_cndmask_b32 v52, v52, v53, vcc
    v_lshlrev_b32 v55, 2, v55
    v_lshrrev_b32 v54, 1, v54
    v_lshl_add_u32 v54, v54, 8, v55
    v_add_u32 v54, 0x200, v54
    v_cmp_le_u32 vcc, 12, v50
    v_subrev_u32 v53, 16, v50
    v_lshlrev_b32 v53, 8, v53
    v_cndmask_b32 v52, v52, v54, vcc
    v_add_u32 v53, 0x400, v53
    v_cmp_le_u32 vcc, 16, v50
    s_nop 1
    v_cndmask_b32 v52, v52, v53, vcc
    v_lshl_add_u32 v52, v51, 3, v52
    v_min_u32 v52, 0x801, v52
    v_cmp_gt_u32 vcc, 0x2a0, v43
    v_mov_b32 v53, 0x801
    s_nop 0
    v_cndmask_b32 v52, v53, v52, vcc
    v_lshlrev_b32 v52, 2, v52
    s_waitcnt lgkmcnt(0)
    v_add_f32 v45, v45, v46
    v_add_f32 v47, v47, v48
    v_add_f32 v45, v45, v47
    ds_write_b32 v52, v45 offset:27648
    s_waitcnt lgkmcnt(0)
    s_barrier
    v_lshlrev_b32 v43, 3, v0
    v_sub_u32 v43, 0x7ff, v43
    v_subrev_u32 v44, 0, v43
    v_cvt_f32_u32 v44, v44
    v_cvt_pk_bf16_f32 v44, v44, v44
    v_lshlrev_b32 v44, 16, v44
    v_cvt_u32_f32 v44, v44
    v_lshlrev_b32 v44, 2, v44
    ds_read_b32 v48, v44 offset:27648
    v_subrev_u32 v44, 1, v43
    v_cvt_f32_u32 v44, v44
    v_cvt_pk_bf16_f32 v44, v44, v44
    v_lshlrev_b32 v44, 16, v44
    v_cvt_u32_f32 v44, v44
    v_lshlrev_b32 v44, 2, v44
    ds_read_b32 v49, v44 offset:27648
    v_subrev_u32 v44, 2, v43
    v_cvt_f32_u32 v44, v44
    v_cvt_pk_bf16_f32 v44, v44, v44
    v_lshlrev_b32 v44, 16, v44
    v_cvt_u32_f32 v44, v44
    v_lshlrev_b32 v44, 2, v44
    ds_read_b32 v50, v44 offset:27648
    v_subrev_u32 v44, 3, v43
    v_cvt_f32_u32 v44, v44
    v_cvt_pk_bf16_f32 v44, v44, v44
    v_lshlrev_b32 v44, 16, v44
    v_cvt_u32_f32 v44, v44
    v_lshlrev_b32 v44, 2, v44
    ds_read_b32 v51, v44 offset:27648
    v_subrev_u32 v44, 4, v43
    v_cvt_f32_u32 v44, v44
    v_cvt_pk_bf16_f32 v44, v44, v44
    v_lshlrev_b32 v44, 16, v44
    v_cvt_u32_f32 v44, v44
    v_lshlrev_b32 v44, 2, v44
    ds_read_b32 v52, v44 offset:27648
    v_subrev_u32 v44, 5, v43
    v_cvt_f32_u32 v44, v44
    v_cvt_pk_bf16_f32 v44, v44, v44
    v_lshlrev_b32 v44, 16, v44
    v_cvt_u32_f32 v44, v44
    v_lshlrev_b32 v44, 2, v44
    ds_read_b32 v53, v44 offset:27648
    v_subrev_u32 v44, 6, v43
    v_cvt_f32_u32 v44, v44
    v_cvt_pk_bf16_f32 v44, v44, v44
    v_lshlrev_b32 v44, 16, v44
    v_cvt_u32_f32 v44, v44
    v_lshlrev_b32 v44, 2, v44
    ds_read_b32 v54, v44 offset:27648
    v_subrev_u32 v44, 7, v43
    v_cvt_f32_u32 v44, v44
    v_cvt_pk_bf16_f32 v44, v44, v44
    v_lshlrev_b32 v44, 16, v44
    v_cvt_u32_f32 v44, v44
    v_lshlrev_b32 v44, 2, v44
    ds_read_b32 v55, v44 offset:27648
    s_lshl_b32 s12, s56, 12
    s_add_u32 s12, s12, 36700160
    v_lshlrev_b32 v44, 4, v0
    s_waitcnt lgkmcnt(0)
    v_cvt_pk_bf16_f32 v56, v48, v49
    v_cvt_pk_bf16_f32 v57, v50, v51
    v_cvt_pk_bf16_f32 v58, v52, v53
    v_cvt_pk_bf16_f32 v59, v54, v55
    buffer_store_dwordx4 v[56:59], v44, s[8:11], s12 offen
    s_endpgm
prep_kernel_to:
    s_mul_i32 s14, s56, 81920
    v_lshlrev_b32 v1, 4, v0
    s_add_u32 s16, s14, 0
    buffer_load_dwordx4 v[8:11], v1, s[52:55], s16 offen
    s_add_u32 s16, s14, 4096
    buffer_load_dwordx4 v[12:15], v1, s[52:55], s16 offen
    s_add_u32 s16, s14, 8192
    buffer_load_dwordx4 v[16:19], v1, s[52:55], s16 offen
    s_add_u32 s16, s14, 12288
    buffer_load_dwordx4 v[20:23], v1, s[52:55], s16 offen
    s_add_u32 s16, s14, 16384
    buffer_load_dwordx4 v[24:27], v1, s[52:55], s16 offen
    s_add_u32 s16, s14, 20480
    buffer_load_dwordx4 v[28:31], v1, s[52:55], s16 offen
    s_add_u32 s16, s14, 24576
    buffer_load_dwordx4 v[32:35], v1, s[52:55], s16 offen
    s_add_u32 s16, s14, 28672
    buffer_load_dwordx4 v[36:39], v1, s[52:55], s16 offen
    s_add_u32 s16, s14, 32768
    buffer_load_dwordx4 v[8:11], v1, s[52:55], s16 offen
    s_add_u32 s16, s14, 36864
    buffer_load_dwordx4 v[12:15], v1, s[52:55], s16 offen
    s_add_u32 s16, s14, 40960
    buffer_load_dwordx4 v[16:19], v1, s[52:55], s16 offen
    s_add_u32 s16, s14, 45056
    buffer_load_dwordx4 v[20:23], v1, s[52:55], s16 offen
    s_add_u32 s16, s14, 49152
    buffer_load_dwordx4 v[24:27], v1, s[52:55], s16 offen
    s_add_u32 s16, s14, 53248
    buffer_load_dwordx4 v[28:31], v1, s[52:55], s16 offen
    s_add_u32 s16, s14, 57344
    buffer_load_dwordx4 v[32:35], v1, s[52:55], s16 offen
    s_add_u32 s16, s14, 61440
    buffer_load_dwordx4 v[36:39], v1, s[52:55], s16 offen
    s_add_u32 s16, s14, 65536
    buffer_load_dwordx4 v[8:11], v1, s[52:55], s16 offen
    s_add_u32 s16, s14, 69632
    buffer_load_dwordx4 v[12:15], v1, s[52:55], s16 offen
    s_add_u32 s16, s14, 73728
    buffer_load_dwordx4 v[16:19], v1, s[52:55], s16 offen
    s_add_u32 s16, s14, 77824
    buffer_load_dwordx4 v[20:23], v1, s[52:55], s16 offen
    s_waitcnt vmcnt(0)
    s_endpgm
prep_kernel_cs:
    s_mul_i32 s14, s56, 40960
    v_lshlrev_b32 v1, 4, v0
    s_add_u32 s16, s14, 0
    buffer_load_dwordx4 v[32:35], v1, s[52:55], s16 offen
    s_add_u32 s16, s14, 4096
    buffer_load_dwordx4 v[36:39], v1, s[52:55], s16 offen
    s_add_u32 s16, s14, 8192
    buffer_load_dwordx4 v[40:43], v1, s[52:55], s16 offen
    s_add_u32 s16, s14, 12288
    buffer_load_dwordx4 v[44:47], v1, s[52:55], s16 offen
    s_add_u32 s16, s14, 16384
    buffer_load_dwordx4 v[48:51], v1, s[52:55], s16 offen
    s_add_u32 s16, s14, 20480
    buffer_load_dwordx4 v[52:55], v1, s[52:55], s16 offen
    s_add_u32 s16, s14, 24576
    buffer_load_dwordx4 v[56:59], v1, s[52:55], s16 offen
    s_add_u32 s16, s14, 28672
    buffer_load_dwordx4 v[60:63], v1, s[52:55], s16 offen
    s_add_u32 s16, s14, 32768
    buffer_load_dwordx4 v[64:67], v1, s[52:55], s16 offen
    s_add_u32 s16, s14, 36864
    buffer_load_dwordx4 v[68:71], v1, s[52:55], s16 offen
    s_cmp_ge_u32 s56, 27
    s_cselect_b32 s44, s48, s44
    s_cselect_b32 s45, s49, s45
    s_cselect_b32 s13, 27, 0
    s_sub_u32 s13, s56, s13
    v_and_b32 v1, 31, v0
    v_lshrrev_b32 v2, 5, v0
    v_mul_u32_u24 v3, 276480, v2
    v_lshl_add_u32 v3, v1, 2, v3
    s_lshl_b32 s14, s13, 7
    v_mov_b32 v4, 0
    v_mov_b32 v5, 0
    s_mov_b32 s41, 0xffff0000
    s_mov_b32 s15, 0
prep_kernel_csl:
    s_add_u32 s16, s14, 0
    buffer_load_dword v8, v3, s[44:47], s16 offen
    s_add_u32 s16, s14, 3456
    buffer_load_dword v9, v3, s[44:47], s16 offen
    s_add_u32 s16, s14, 6912
    buffer_load_dword v10, v3, s[44:47], s16 offen
    s_add_u32 s16, s14, 10368
    buffer_load_dword v11, v3, s[44:47], s16 offen
    s_add_u32 s16, s14, 13824
    buffer_load_dword v12, v3, s[44:47], s16 offen
    s_add_u32 s16, s14, 17280
    buffer_load_dword v13, v3, s[44:47], s16 offen
    s_add_u32 s16, s14, 20736
    buffer_load_dword v14, v3, s[44:47], s16 offen
    s_add_u32 s16, s14, 24192
    buffer_load_dword v15, v3, s[44:47], s16 offen
    s_add_u32 s16, s14, 27648
    buffer_load_dword v16, v3, s[44:47], s16 offen
    s_add_u32 s16, s14, 31104
    buffer_load_dword v17, v3, s[44:47], s16 offen
    s_add_u32 s16, s14, 34560
    buffer_load_dword v18, v3, s[44:47], s16 offen
    s_add_u32 s16, s14, 38016
    buffer_load_dword v19, v3, s[44:47], s16 offen
    s_add_u32 s16, s14, 41472
    buffer_load_dword v20, v3, s[44:47], s16 offen
    s_add_u32 s16, s14, 44928
    buffer_load_dword v21, v3, s[44:47], s16 offen
    s_add_u32 s16, s14, 48384
    buffer_load_dword v22, v3, s[44:47], s16 offen
    s_add_u32 s16, s14, 51840
    buffer_load_dword v23, v3, s[44:47], s16 offen
    s_add_u32 s14, s14, 55296
    s_waitcnt vmcnt(15)
    v_lshlrev_b32 v6, 16, v8
    v_and_b32 v7, s41, v8
    v_add_f32 v4, v4, v6
    v_add_f32 v5, v5, v7
    s_waitcnt vmcnt(14)
    v_lshlrev_b32 v6, 16, v9
    v_and_b32 v7, s41, v9
    v_add_f32 v4, v4, v6
    v_add_f32 v5, v5, v7
    s_waitcnt vmcnt(13)
    v_lshlrev_b32 v6, 16, v10
    v_and_b32 v7, s41, v10
    v_add_f32 v4, v4, v6
    v_add_f32 v5, v5, v7
    s_waitcnt vmcnt(12)
    v_lshlrev_b32 v6, 16, v11
    v_and_b32 v7, s41, v11
    v_add_f32 v4, v4, v6
    v_add_f32 v5, v5, v7
    s_waitcnt vmcnt(11)
    v_lshlrev_b32 v6, 16, v12
    v_and_b32 v7, s41, v12
    v_add_f32 v4, v4, v6
    v_add_f32 v5, v5, v7
    s_waitcnt vmcnt(10)
    v_lshlrev_b32 v6, 16, v13
    v_and_b32 v7, s41, v13
    v_add_f32 v4, v4, v6
    v_add_f32 v5, v5, v7
    s_waitcnt vmcnt(9)
    v_lshlrev_b32 v6, 16, v14
    v_and_b32 v7, s41, v14
    v_add_f32 v4, v4, v6
    v_add_f32 v5, v5, v7
    s_waitcnt vmcnt(8)
    v_lshlrev_b32 v6, 16, v15
    v_and_b32 v7, s41, v15
    v_add_f32 v4, v4, v6
    v_add_f32 v5, v5, v7
    s_waitcnt vmcnt(7)
    v_lshlrev_b32 v6, 16, v16
    v_and_b32 v7, s41, v16
    v_add_f32 v4, v4, v6
    v_add_f32 v5, v5, v7
    s_waitcnt vmcnt(6)
    v_lshlrev_b32 v6, 16, v17
    v_and_b32 v7, s41, v17
    v_add_f32 v4, v4, v6
    v_add_f32 v5, v5, v7
    s_waitcnt vmcnt(5)
    v_lshlrev_b32 v6, 16, v18
    v_and_b32 v7, s41, v18
    v_add_f32 v4, v4, v6
    v_add_f32 v5, v5, v7
    s_waitcnt vmcnt(4)
    v_lshlrev_b32 v6, 16, v19
    v_and_b32 v7, s41, v19
    v_add_f32 v4, v4, v6
    v_add_f32 v5, v5, v7
    s_waitcnt vmcnt(3)
    v_lshlrev_b32 v6, 16, v20
    v_and_b32 v7, s41, v20
    v_add_f32 v4, v4, v6
    v_add_f32 v5, v5, v7
    s_waitcnt vmcnt(2)
    v_lshlrev_b32 v6, 16, v21
    v_and_b32 v7, s41, v21
    v_add_f32 v4, v4, v6
    v_add_f32 v5, v5, v7
    s_waitcnt vmcnt(1)
    v_lshlrev_b32 v6, 16, v22
    v_and_b32 v7, s41, v22
    v_add_f32 v4, v4, v6
    v_add_f32 v5, v5, v7
    s_waitcnt vmcnt(0)
    v_lshlrev_b32 v6, 16, v23
    v_and_b32 v7, s41, v23
    v_add_f32 v4, v4, v6
    v_add_f32 v5, v5, v7
    s_add_u32 s15, s15, 1
    s_cmp_lt_u32 s15, 5
    s_cbranch_scc1 prep_kernel_csl
    v_lshlrev_b32 v6, 3, v0
    ds_write_b64 v6, v[4:5]
    s_waitcnt lgkmcnt(0)
    s_barrier
    v_lshlrev_b32 v6, 3, v1
    ds_read_b64 v[8:9], v6 offset:0
    ds_read_b64 v[10:11], v6 offset:256
    ds_read_b64 v[12:13], v6 offset:512
    ds_read_b64 v[14:15], v6 offset:768
    ds_read_b64 v[16:17], v6 offset:1024
    ds_read_b64 v[18:19], v6 offset:1280
    ds_read_b64 v[20:21], v6 offset:1536
    ds_read_b64 v[22:23], v6 offset:1792
    s_waitcnt lgkmcnt(0)
    v_add_f32 v8, v8, v10
    v_add_f32 v9, v9, v11
    v_add_f32 v8, v8, v12
    v_add_f32 v9, v9, v13
    v_add_f32 v8, v8, v14
    v_add_f32 v9, v9, v15
    v_add_f32 v8, v8, v16
    v_add_f32 v9, v9, v17
    v_add_f32 v8, v8, v18
    v_add_f32 v9, v9, v19
    v_add_f32 v8, v8, v20
    v_add_f32 v9, v9, v21
    v_add_f32 v8, v8, v22
    v_add_f32 v9, v9, v23
    s_lshl_b32 s14, s56, 8
    s_add_u32 s14, s14, 42991616
    v_cmp_gt_u32 vcc, 32, v0
    s_and_saveexec_b64 s[16:17], vcc
    s_cbranch_execz prep_kernel_end
    buffer_store_dwordx2 v[8:9], v6, s[8:11], s14 offen
    s_endpgm
prep_kernel_ln1:
    v_and_b32 v1, 63, v0
    v_lshrrev_b32 v2, 6, v0
    s_lshl_b32 s3, s2, 5
    v_lshlrev_b32 v4, 3, v2
    v_add_u32 v4, s3, v4
    s_movk_i32 s12, 1280
    v_mul_lo_u32 v3, v4, s12
    v_lshl_add_u32 v3, v1, 2, v3
    s_movk_i32 s13, 0
    buffer_load_dword v64, v3, s[4:7], s13 offen offset:0
    buffer_load_dword v65, v3, s[4:7], s13 offen offset:256
    buffer_load_dword v66, v3, s[4:7], s13 offen offset:512
    buffer_load_dword v67, v3, s[4:7], s13 offen offset:768
    buffer_load_dword v68, v3, s[4:7], s13 offen offset:1024
    s_movk_i32 s13, 1280
    buffer_load_dword v69, v3, s[4:7], s13 offen offset:0
    buffer_load_dword v70, v3, s[4:7], s13 offen offset:256
    buffer_load_dword v71, v3, s[4:7], s13 offen offset:512
    buffer_load_dword v72, v3, s[4:7], s13 offen offset:768
    buffer_load_dword v73, v3, s[4:7], s13 offen offset:1024
    s_movk_i32 s13, 2560
    buffer_load_dword v74, v3, s[4:7], s13 offen offset:0
    buffer_load_dword v75, v3, s[4:7], s13 offen offset:256
    buffer_load_dword v76, v3, s[4:7], s13 offen offset:512
    buffer_load_dword v77, v3, s[4:7], s13 offen offset:768
    buffer_load_dword v78, v3, s[4:7], s13 offen offset:1024
    s_movk_i32 s13, 3840
    buffer_load_dword v79, v3, s[4:7], s13 offen offset:0
    buffer_load_dword v80, v3, s[4:7], s13 offen offset:256
    buffer_load_dword v81, v3, s[4:7], s13 offen offset:512
    buffer_load_dword v82, v3, s[4:7], s13 offen offset:768
    buffer_load_dword v83, v3, s[4:7], s13 offen offset:1024
    s_movk_i32 s13, 5120
    buffer_load_dword v84, v3, s[4:7], s13 offen offset:0
    buffer_load_dword v85, v3, s[4:7], s13 offen offset:256
    buffer_load_dword v86, v3, s[4:7], s13 offen offset:512
    buffer_load_dword v87, v3, s[4:7], s13 offen offset:768
    buffer_load_dword v88, v3, s[4:7], s13 offen offset:1024
    s_movk_i32 s13, 6400
    buffer_load_dword v89, v3, s[4:7], s13 offen offset:0
    buffer_load_dword v90, v3, s[4:7], s13 offen offset:256
    buffer_load_dword v91, v3, s[4:7], s13 offen offset:512
    buffer_load_dword v92, v3, s[4:7], s13 offen offset:768
    buffer_load_dword v93, v3, s[4:7], s13 offen offset:1024
    s_movk_i32 s13, 7680
    buffer_load_dword v94, v3, s[4:7], s13 offen offset:0
    buffer_load_dword v95, v3, s[4:7], s13 offen offset:256
    buffer_load_dword v96, v3, s[4:7], s13 offen offset:512
    buffer_load_dword v97, v3, s[4:7], s13 offen offset:768
    buffer_load_dword v98, v3, s[4:7], s13 offen offset:1024
    s_movk_i32 s13, 8960
    buffer_load_dword v99, v3, s[4:7], s13 offen offset:0
    buffer_load_dword v100, v3, s[4:7], s13 offen offset:256
    buffer_load_dword v101, v3, s[4:7], s13 offen offset:512
    buffer_load_dword v102, v3, s[4:7], s13 offen offset:768
    buffer_load_dword v103, v3, s[4:7], s13 offen offset:1024
    v_xor_b32 v48, 1, v1
    v_lshlrev_b32 v48, 2, v48
    v_xor_b32 v49, 2, v1
    v_lshlrev_b32 v49, 2, v49
    v_xor_b32 v50, 4, v1
    v_lshlrev_b32 v50, 2, v50
    v_xor_b32 v51, 8, v1
    v_lshlrev_b32 v51, 2, v51
    v_xor_b32 v52, 16, v1
    v_lshlrev_b32 v52, 2, v52
    v_xor_b32 v53, 32, v1
    v_lshlrev_b32 v53, 2, v53
    s_mov_b32 s41, 0xffff0000
    v_mul_u32_u24 v8, 160, v1
    v_lshl_add_u32 v8, v2, 4, v8
    v_lshrrev_b32 v9, 2, v0
    v_and_b32 v11, 3, v0
    v_lshlrev_b32 v10, 12, v9
    v_lshl_add_u32 v10, v11, 4, v10
    s_lshl_b32 s3, s2, 6
    v_add_u32 v10, s3, v10
    v_mul_u32_u24 v9, 80, v9
    v_lshl_add_u32 v9, v11, 4, v9
    s_waitcnt vmcnt(0)
    v_and_b32 v6, 0xffff, v64
    v_lshl_or_b32 v104, v69, 16, v6
    v_lshrrev_b32 v6, 16, v64
    v_and_or_b32 v108, v69, s41, v6
    v_and_b32 v6, 0xffff, v74
    v_lshl_or_b32 v105, v79, 16, v6
    v_lshrrev_b32 v6, 16, v74
    v_and_or_b32 v109, v79, s41, v6
    v_and_b32 v6, 0xffff, v84
    v_lshl_or_b32 v106, v89, 16, v6
    v_lshrrev_b32 v6, 16, v84
    v_and_or_b32 v110, v89, s41, v6
    v_and_b32 v6, 0xffff, v94
    v_lshl_or_b32 v107, v99, 16, v6
    v_lshrrev_b32 v6, 16, v94
    v_and_or_b32 v111, v99, s41, v6
    ds_write_b128 v8, v[104:107] offset:0
    ds_write_b128 v8, v[108:111] offset:80
    v_and_b32 v6, 0xffff, v65
    v_lshl_or_b32 v104, v70, 16, v6
    v_lshrrev_b32 v6, 16, v65
    v_and_or_b32 v108, v70, s41, v6
    v_and_b32 v6, 0xffff, v75
    v_lshl_or_b32 v105, v80, 16, v6
    v_lshrrev_b32 v6, 16, v75
    v_and_or_b32 v109, v80, s41, v6
    v_and_b32 v6, 0xffff, v85
    v_lshl_or_b32 v106, v90, 16, v6
    v_lshrrev_b32 v6, 16, v85
    v_and_or_b32 v110, v90, s41, v6
    v_and_b32 v6, 0xffff, v95
    v_lshl_or_b32 v107, v100, 16, v6
    v_lshrrev_b32 v6, 16, v95
    v_and_or_b32 v111, v100, s41, v6
    ds_write_b128 v8, v[104:107] offset:10240
    ds_write_b128 v8, v[108:111] offset:10320
    v_and_b32 v6, 0xffff, v66
    v_lshl_or_b32 v104, v71, 16, v6
    v_lshrrev_b32 v6, 16, v66
    v_and_or_b32 v108, v71, s41, v6
    v_and_b32 v6, 0xffff, v76
    v_lshl_or_b32 v105, v81, 16, v6
    v_lshrrev_b32 v6, 16, v76
    v_and_or_b32 v109, v81, s41, v6
    v_and_b32 v6, 0xffff, v86
    v_lshl_or_b32 v106, v91, 16, v6
    v_lshrrev_b32 v6, 16, v86
    v_and_or_b32 v110, v91, s41, v6
    v_and_b32 v6, 0xffff, v96
    v_lshl_or_b32 v107, v101, 16, v6
    v_lshrrev_b32 v6, 16, v96
    v_and_or_b32 v111, v101, s41, v6
    ds_write_b128 v8, v[104:107] offset:20480
    ds_write_b128 v8, v[108:111] offset:20560
    v_and_b32 v6, 0xffff, v67
    v_lshl_or_b32 v104, v72, 16, v6
    v_lshrrev_b32 v6, 16, v67
    v_and_or_b32 v108, v72, s41, v6
    v_and_b32 v6, 0xffff, v77
    v_lshl_or_b32 v105, v82, 16, v6
    v_lshrrev_b32 v6, 16, v77
    v_and_or_b32 v109, v82, s41, v6
    v_and_b32 v6, 0xffff, v87
    v_lshl_or_b32 v106, v92, 16, v6
    v_lshrrev_b32 v6, 16, v87
    v_and_or_b32 v110, v92, s41, v6
    v_and_b32 v6, 0xffff, v97
    v_lshl_or_b32 v107, v102, 16, v6
    v_lshrrev_b32 v6, 16, v97
    v_and_or_b32 v111, v102, s41, v6
    ds_write_b128 v8, v[104:107] offset:30720
    ds_write_b128 v8, v[108:111] offset:30800
    v_and_b32 v6, 0xffff, v68
    v_lshl_or_b32 v104, v73, 16, v6
    v_lshrrev_b32 v6, 16, v68
    v_and_or_b32 v108, v73, s41, v6
    v_and_b32 v6, 0xffff, v78
    v_lshl_or_b32 v105, v83, 16, v6
    v_lshrrev_b32 v6, 16, v78
    v_and_or_b32 v109, v83, s41, v6
    v_and_b32 v6, 0xffff, v88
    v_lshl_or_b32 v106, v93, 16, v6
    v_lshrrev_b32 v6, 16, v88
    v_and_or_b32 v110, v93, s41, v6
    v_and_b32 v6, 0xffff, v98
    v_lshl_or_b32 v107, v103, 16, v6
    v_lshrrev_b32 v6, 16, v98
    v_and_or_b32 v111, v103, s41, v6
    ds_write_b128 v8, v[104:107] offset:40960
    ds_write_b128 v8, v[108:111] offset:41040
    s_waitcnt lgkmcnt(0)
    s_barrier
    ds_read_b128 v[104:107], v9 offset:0
    s_mov_b32 s15, 3145728
    s_waitcnt lgkmcnt(0)
    buffer_store_dwordx4 v[104:107], v10, s[8:11], s15 offen
    ds_read_b128 v[108:111], v9 offset:5120
    s_mov_b32 s15, 3407872
    s_waitcnt lgkmcnt(0)
    buffer_store_dwordx4 v[108:111], v10, s[8:11], s15 offen
    ds_read_b128 v[112:115], v9 offset:10240
    s_mov_b32 s15, 3670016
    s_waitcnt lgkmcnt(0)
    buffer_store_dwordx4 v[112:115], v10, s[8:11], s15 offen
    ds_read_b128 v[116:119], v9 offset:15360
    s_mov_b32 s15, 3932160
    s_waitcnt lgkmcnt(0)
    buffer_store_dwordx4 v[116:119], v10, s[8:11], s15 offen
    ds_read_b128 v[104:107], v9 offset:20480
    s_mov_b32 s15, 4194304
    s_waitcnt lgkmcnt(0)
    buffer_store_dwordx4 v[104:107], v10, s[8:11], s15 offen
    ds_read_b128 v[108:111], v9 offset:25600
    s_mov_b32 s15, 4456448
    s_waitcnt lgkmcnt(0)
    buffer_store_dwordx4 v[108:111], v10, s[8:11], s15 offen
    ds_read_b128 v[112:115], v9 offset:30720
    s_mov_b32 s15, 4718592
    s_waitcnt lgkmcnt(0)
    buffer_store_dwordx4 v[112:115], v10, s[8:11], s15 offen
    ds_read_b128 v[116:119], v9 offset:35840
    s_mov_b32 s15, 4980736
    s_waitcnt lgkmcnt(0)
    buffer_store_dwordx4 v[116:119], v10, s[8:11], s15 offen
    ds_read_b128 v[104:107], v9 offset:40960
    s_mov_b32 s15, 5242880
    s_waitcnt lgkmcnt(0)
    buffer_store_dwordx4 v[104:107], v10, s[8:11], s15 offen
    ds_read_b128 v[108:111], v9 offset:46080
    s_mov_b32 s15, 5505024
    s_waitcnt lgkmcnt(0)
    buffer_store_dwordx4 v[108:111], v10, s[8:11], s15 offen
    s_barrier
    s_mov_b32 s40, 0x3acccccd
    v_mov_b32 v6, 0x3f803f80
    v_mov_b32 v16, 0
    v_mov_b32 v112, 0
    v_mov_b32 v17, 0
    v_mov_b32 v113, 0
    v_mov_b32 v18, 0
    v_mov_b32 v114, 0
    v_mov_b32 v19, 0
    v_mov_b32 v115, 0
    v_mov_b32 v20, 0
    v_mov_b32 v116, 0
    v_mov_b32 v21, 0
    v_mov_b32 v117, 0
    v_mov_b32 v22, 0
    v_mov_b32 v118, 0
    v_mov_b32 v23, 0
    v_mov_b32 v119, 0
    v_dot2c_f32_bf16 v16, v64, v6
    v_dot2c_f32_bf16 v112, v64, v64
    v_dot2c_f32_bf16 v17, v69, v6
    v_dot2c_f32_bf16 v113, v69, v69
    v_dot2c_f32_bf16 v18, v74, v6
    v_dot2c_f32_bf16 v114, v74, v74
    v_dot2c_f32_bf16 v19, v79, v6
    v_dot2c_f32_bf16 v115, v79, v79
    v_dot2c_f32_bf16 v20, v84, v6
    v_dot2c_f32_bf16 v116, v84, v84
    v_dot2c_f32_bf16 v21, v89, v6
    v_dot2c_f32_bf16 v117, v89, v89
    v_dot2c_f32_bf16 v22, v94, v6
    v_dot2c_f32_bf16 v118, v94, v94
    v_dot2c_f32_bf16 v23, v99, v6
    v_dot2c_f32_bf16 v119, v99, v99
    v_dot2c_f32_bf16 v16, v65, v6
    v_dot2c_f32_bf16 v112, v65, v65
    v_dot2c_f32_bf16 v17, v70, v6
    v_dot2c_f32_bf16 v113, v70, v70
    v_dot2c_f32_bf16 v18, v75, v6
    v_dot2c_f32_bf16 v114, v75, v75
    v_dot2c_f32_bf16 v19, v80, v6
    v_dot2c_f32_bf16 v115, v80, v80
    v_dot2c_f32_bf16 v20, v85, v6
    v_dot2c_f32_bf16 v116, v85, v85
    v_dot2c_f32_bf16 v21, v90, v6
    v_dot2c_f32_bf16 v117, v90, v90
    v_dot2c_f32_bf16 v22, v95, v6
    v_dot2c_f32_bf16 v118, v95, v95
    v_dot2c_f32_bf16 v23, v100, v6
    v_dot2c_f32_bf16 v119, v100, v100
    v_dot2c_f32_bf16 v16, v66, v6
    v_dot2c_f32_bf16 v112, v66, v66
    v_dot2c_f32_bf16 v17, v71, v6
    v_dot2c_f32_bf16 v113, v71, v71
    v_dot2c_f32_bf16 v18, v76, v6
    v_dot2c_f32_bf16 v114, v76, v76
    v_dot2c_f32_bf16 v19, v81, v6
    v_dot2c_f32_bf16 v115, v81, v81
    v_dot2c_f32_bf16 v20, v86, v6
    v_dot2c_f32_bf16 v116, v86, v86
    v_dot2c_f32_bf16 v21, v91, v6
    v_dot2c_f32_bf16 v117, v91, v91
    v_dot2c_f32_bf16 v22, v96, v6
    v_dot2c_f32_bf16 v118, v96, v96
    v_dot2c_f32_bf16 v23, v101, v6
    v_dot2c_f32_bf16 v119, v101, v101
    v_dot2c_f32_bf16 v16, v67, v6
    v_dot2c_f32_bf16 v112, v67, v67
    v_dot2c_f32_bf16 v17, v72, v6
    v_dot2c_f32_bf16 v113, v72, v72
    v_dot2c_f32_bf16 v18, v77, v6
    v_dot2c_f32_bf16 v114, v77, v77
    v_dot2c_f32_bf16 v19, v82, v6
    v_dot2c_f32_bf16 v115, v82, v82
    v_dot2c_f32_bf16 v20, v87, v6
    v_dot2c_f32_bf16 v116, v87, v87
    v_dot2c_f32_bf16 v21, v92, v6
    v_dot2c_f32_bf16 v117, v92, v92
    v_dot2c_f32_bf16 v22, v97, v6
    v_dot2c_f32_bf16 v118, v97, v97
    v_dot2c_f32_bf16 v23, v102, v6
    v_dot2c_f32_bf16 v119, v102, v102
    v_dot2c_f32_bf16 v16, v68, v6
    v_dot2c_f32_bf16 v112, v68, v68
    v_dot2c_f32_bf16 v17, v73, v6
    v_dot2c_f32_bf16 v113, v73, v73
    v_dot2c_f32_bf16 v18, v78, v6
    v_dot2c_f32_bf16 v114, v78, v78
    v_dot2c_f32_bf16 v19, v83, v6
    v_dot2c_f32_bf16 v115, v83, v83
    v_dot2c_f32_bf16 v20, v88, v6
    v_dot2c_f32_bf16 v116, v88, v88
    v_dot2c_f32_bf16 v21, v93, v6
    v_dot2c_f32_bf16 v117, v93, v93
    v_dot2c_f32_bf16 v22, v98, v6
    v_dot2c_f32_bf16 v118, v98, v98
    v_dot2c_f32_bf16 v23, v103, v6
    v_dot2c_f32_bf16 v119, v103, v103
    s_nop 2
    ds_bpermute_b32 v24, v48, v16
    ds_bpermute_b32 v25, v48, v17
    ds_bpermute_b32 v26, v48, v18
    ds_bpermute_b32 v27, v48, v19
    ds_bpermute_b32 v28, v48, v20
    ds_bpermute_b32 v29, v48, v21
    ds_bpermute_b32 v30, v48, v22
    ds_bpermute_b32 v31, v48, v23
    ds_bpermute_b32 v120, v48, v112
    ds_bpermute_b32 v121, v48, v113
    ds_bpermute_b32 v122, v48, v114
    ds_bpermute_b32 v123, v48, v115
    ds_bpermute_b32 v124, v48, v116
    ds_bpermute_b32 v125, v48, v117
    ds_bpermute_b32 v126, v48, v118
    ds_bpermute_b32 v127, v48, v119
    s_waitcnt lgkmcnt(8)
    v_add_f32 v16, v16, v24
    v_add_f32 v17, v17, v25
    v_add_f32 v18, v18, v26
    v_add_f32 v19, v19, v27
    v_add_f32 v20, v20, v28
    v_add_f32 v21, v21, v29
    v_add_f32 v22, v22, v30
    v_add_f32 v23, v23, v31
    s_waitcnt lgkmcnt(0)
    v_add_f32 v112, v112, v120
    v_add_f32 v113, v113, v121
    v_add_f32 v114, v114, v122
    v_add_f32 v115, v115, v123
    v_add_f32 v116, v116, v124
    v_add_f32 v117, v117, v125
    v_add_f32 v118, v118, v126
    v_add_f32 v119, v119, v127
    ds_bpermute_b32 v24, v49, v16
    ds_bpermute_b32 v25, v49, v17
    ds_bpermute_b32 v26, v49, v18
    ds_bpermute_b32 v27, v49, v19
    ds_bpermute_b32 v28, v49, v20
    ds_bpermute_b32 v29, v49, v21
    ds_bpermute_b32 v30, v49, v22
    ds_bpermute_b32 v31, v49, v23
    ds_bpermute_b32 v120, v49, v112
    ds_bpermute_b32 v121, v49, v113
    ds_bpermute_b32 v122, v49, v114
    ds_bpermute_b32 v123, v49, v115
    ds_bpermute_b32 v124, v49, v116
    ds_bpermute_b32 v125, v49, v117
    ds_bpermute_b32 v126, v49, v118
    ds_bpermute_b32 v127, v49, v119
    s_waitcnt lgkmcnt(8)
    v_add_f32 v16, v16, v24
    v_add_f32 v17, v17, v25
    v_add_f32 v18, v18, v26
    v_add_f32 v19, v19, v27
    v_add_f32 v20, v20, v28
    v_add_f32 v21, v21, v29
    v_add_f32 v22, v22, v30
    v_add_f32 v23, v23, v31
    s_waitcnt lgkmcnt(0)
    v_add_f32 v112, v112, v120
    v_add_f32 v113, v113, v121
    v_add_f32 v114, v114, v122
    v_add_f32 v115, v115, v123
    v_add_f32 v116, v116, v124
    v_add_f32 v117, v117, v125
    v_add_f32 v118, v118, v126
    v_add_f32 v119, v119, v127
    ds_bpermute_b32 v24, v50, v16
    ds_bpermute_b32 v25, v50, v17
    ds_bpermute_b32 v26, v50, v18
    ds_bpermute_b32 v27, v50, v19
    ds_bpermute_b32 v28, v50, v20
    ds_bpermute_b32 v29, v50, v21
    ds_bpermute_b32 v30, v50, v22
    ds_bpermute_b32 v31, v50, v23
    ds_bpermute_b32 v120, v50, v112
    ds_bpermute_b32 v121, v50, v113
    ds_bpermute_b32 v122, v50, v114
    ds_bpermute_b32 v123, v50, v115
    ds_bpermute_b32 v124, v50, v116
    ds_bpermute_b32 v125, v50, v117
    ds_bpermute_b32 v126, v50, v118
    ds_bpermute_b32 v127, v50, v119
    s_waitcnt lgkmcnt(8)
    v_add_f32 v16, v16, v24
    v_add_f32 v17, v17, v25
    v_add_f32 v18, v18, v26
    v_add_f32 v19, v19, v27
    v_add_f32 v20, v20, v28
    v_add_f32 v21, v21, v29
    v_add_f32 v22, v22, v30
    v_add_f32 v23, v23, v31
    s_waitcnt lgkmcnt(0)
    v_add_f32 v112, v112, v120
    v_add_f32 v113, v113, v121
    v_add_f32 v114, v114, v122
    v_add_f32 v115, v115, v123
    v_add_f32 v116, v116, v124
    v_add_f32 v117, v117, v125
    v_add_f32 v118, v118, v126
    v_add_f32 v119, v119, v127
    ds_bpermute_b32 v24, v51, v16
    ds_bpermute_b32 v25, v51, v17
    ds_bpermute_b32 v26, v51, v18
    ds_bpermute_b32 v27, v51, v19
    ds_bpermute_b32 v28, v51, v20
    ds_bpermute_b32 v29, v51, v21
    ds_bpermute_b32 v30, v51, v22
    ds_bpermute_b32 v31, v51, v23
    ds_bpermute_b32 v120, v51, v112
    ds_bpermute_b32 v121, v51, v113
    ds_bpermute_b32 v122, v51, v114
    ds_bpermute_b32 v123, v51, v115
    ds_bpermute_b32 v124, v51, v116
    ds_bpermute_b32 v125, v51, v117
    ds_bpermute_b32 v126, v51, v118
    ds_bpermute_b32 v127, v51, v119
    s_waitcnt lgkmcnt(8)
    v_add_f32 v16, v16, v24
    v_add_f32 v17, v17, v25
    v_add_f32 v18, v18, v26
    v_add_f32 v19, v19, v27
    v_add_f32 v20, v20, v28
    v_add_f32 v21, v21, v29
    v_add_f32 v22, v22, v30
    v_add_f32 v23, v23, v31
    s_waitcnt lgkmcnt(0)
    v_add_f32 v112, v112, v120
    v_add_f32 v113, v113, v121
    v_add_f32 v114, v114, v122
    v_add_f32 v115, v115, v123
    v_add_f32 v116, v116, v124
    v_add_f32 v117, v117, v125
    v_add_f32 v118, v118, v126
    v_add_f32 v119, v119, v127
    ds_bpermute_b32 v24, v52, v16
    ds_bpermute_b32 v25, v52, v17
    ds_bpermute_b32 v26, v52, v18
    ds_bpermute_b32 v27, v52, v19
    ds_bpermute_b32 v28, v52, v20
    ds_bpermute_b32 v29, v52, v21
    ds_bpermute_b32 v30, v52, v22
    ds_bpermute_b32 v31, v52, v23
    ds_bpermute_b32 v120, v52, v112
    ds_bpermute_b32 v121, v52, v113
    ds_bpermute_b32 v122, v52, v114
    ds_bpermute_b32 v123, v52, v115
    ds_bpermute_b32 v124, v52, v116
    ds_bpermute_b32 v125, v52, v117
    ds_bpermute_b32 v126, v52, v118
    ds_bpermute_b32 v127, v52, v119
    s_waitcnt lgkmcnt(8)
    v_add_f32 v16, v16, v24
    v_add_f32 v17, v17, v25
    v_add_f32 v18, v18, v26
    v_add_f32 v19, v19, v27
    v_add_f32 v20, v20, v28
    v_add_f32 v21, v21, v29
    v_add_f32 v22, v22, v30
    v_add_f32 v23, v23, v31
    s_waitcnt lgkmcnt(0)
    v_add_f32 v112, v112, v120
    v_add_f32 v113, v113, v121
    v_add_f32 v114, v114, v122
    v_add_f32 v115, v115, v123
    v_add_f32 v116, v116, v124
    v_add_f32 v117, v117, v125
    v_add_f32 v118, v118, v126
    v_add_f32 v119, v119, v127
    ds_bpermute_b32 v24, v53, v16
    ds_bpermute_b32 v25, v53, v17
    ds_bpermute_b32 v26, v53, v18
    ds_bpermute_b32 v27, v53, v19
    ds_bpermute_b32 v28, v53, v20
    ds_bpermute_b32 v29, v53, v21
    ds_bpermute_b32 v30, v53, v22
    ds_bpermute_b32 v31, v53, v23
    ds_bpermute_b32 v120, v53, v112
    ds_bpermute_b32 v121, v53, v113
    ds_bpermute_b32 v122, v53, v114
    ds_bpermute_b32 v123, v53, v115
    ds_bpermute_b32 v124, v53, v116
    ds_bpermute_b32 v125, v53, v117
    ds_bpermute_b32 v126, v53, v118
    ds_bpermute_b32 v127, v53, v119
    s_waitcnt lgkmcnt(8)
    v_add_f32 v16, v16, v24
    v_add_f32 v17, v17, v25
    v_add_f32 v18, v18, v26
    v_add_f32 v19, v19, v27
    v_add_f32 v20, v20, v28
    v_add_f32 v21, v21, v29
    v_add_f32 v22, v22, v30
    v_add_f32 v23, v23, v31
    s_waitcnt lgkmcnt(0)
    v_add_f32 v112, v112, v120
    v_add_f32 v113, v113, v121
    v_add_f32 v114, v114, v122
    v_add_f32 v115, v115, v123
    v_add_f32 v116, v116, v124
    v_add_f32 v117, v117, v125
    v_add_f32 v118, v118, v126
    v_add_f32 v119, v119, v127
    v_mul_f32 v32, s40, v16
    v_mul_f32 v24, s40, v112
    v_fma_f32 v24, -v32, v32, v24
    v_max_f32 v24, 0, v24
    v_cvt_pk_bf16_f32 v24, v24, v32
    v_and_b32 v32, s41, v24
    v_lshlrev_b32 v24, 16, v24
    v_add_f32 v24, 0x3727c5ac, v24
    v_cvt_pk_bf16_f32 v24, v24, v24
    v_lshlrev_b32 v24, 16, v24
    v_mul_f32 v33, s40, v17
    v_mul_f32 v25, s40, v113
    v_fma_f32 v25, -v33, v33, v25
    v_max_f32 v25, 0, v25
    v_cvt_pk_bf16_f32 v25, v25, v33
    v_and_b32 v33, s41, v25
    v_lshlrev_b32 v25, 16, v25
    v_add_f32 v25, 0x3727c5ac, v25
    v_cvt_pk_bf16_f32 v25, v25, v25
    v_lshlrev_b32 v25, 16, v25
    v_mul_f32 v34, s40, v18
    v_mul_f32 v26, s40, v114
    v_fma_f32 v26, -v34, v34, v26
    v_max_f32 v26, 0, v26
    v_cvt_pk_bf16_f32 v26, v26, v34
    v_and_b32 v34, s41, v26
    v_lshlrev_b32 v26, 16, v26
    v_add_f32 v26, 0x3727c5ac, v26
    v_cvt_pk_bf16_f32 v26, v26, v26
    v_lshlrev_b32 v26, 16, v26
    v_mul_f32 v35, s40, v19
    v_mul_f32 v27, s40, v115
    v_fma_f32 v27, -v35, v35, v27
    v_max_f32 v27, 0, v27
    v_cvt_pk_bf16_f32 v27, v27, v35
    v_and_b32 v35, s41, v27
    v_lshlrev_b32 v27, 16, v27
    v_add_f32 v27, 0x3727c5ac, v27
    v_cvt_pk_bf16_f32 v27, v27, v27
    v_lshlrev_b32 v27, 16, v27
    v_mul_f32 v36, s40, v20
    v_mul_f32 v28, s40, v116
    v_fma_f32 v28, -v36, v36, v28
    v_max_f32 v28, 0, v28
    v_cvt_pk_bf16_f32 v28, v28, v36
    v_and_b32 v36, s41, v28
    v_lshlrev_b32 v28, 16, v28
    v_add_f32 v28, 0x3727c5ac, v28
    v_cvt_pk_bf16_f32 v28, v28, v28
    v_lshlrev_b32 v28, 16, v28
    v_mul_f32 v37, s40, v21
    v_mul_f32 v29, s40, v117
    v_fma_f32 v29, -v37, v37, v29
    v_max_f32 v29, 0, v29
    v_cvt_pk_bf16_f32 v29, v29, v37
    v_and_b32 v37, s41, v29
    v_lshlrev_b32 v29, 16, v29
    v_add_f32 v29, 0x3727c5ac, v29
    v_cvt_pk_bf16_f32 v29, v29, v29
    v_lshlrev_b32 v29, 16, v29
    v_mul_f32 v38, s40, v22
    v_mul_f32 v30, s40, v118
    v_fma_f32 v30, -v38, v38, v30
    v_max_f32 v30, 0, v30
    v_cvt_pk_bf16_f32 v30, v30, v38
    v_and_b32 v38, s41, v30
    v_lshlrev_b32 v30, 16, v30
    v_add_f32 v30, 0x3727c5ac, v30
    v_cvt_pk_bf16_f32 v30, v30, v30
    v_lshlrev_b32 v30, 16, v30
    v_mul_f32 v39, s40, v23
    v_mul_f32 v31, s40, v119
    v_fma_f32 v31, -v39, v39, v31
    v_max_f32 v31, 0, v31
    v_cvt_pk_bf16_f32 v31, v31, v39
    v_and_b32 v39, s41, v31
    v_lshlrev_b32 v31, 16, v31
    v_add_f32 v31, 0x3727c5ac, v31
    v_cvt_pk_bf16_f32 v31, v31, v31
    v_lshlrev_b32 v31, 16, v31
    v_sqrt_f32 v24, v24
    v_sqrt_f32 v25, v25
    v_sqrt_f32 v26, v26
    v_sqrt_f32 v27, v27
    v_sqrt_f32 v28, v28
    v_sqrt_f32 v29, v29
    v_sqrt_f32 v30, v30
    v_sqrt_f32 v31, v31
    s_nop 0
    v_cvt_pk_bf16_f32 v24, v24, v24
    v_lshlrev_b32 v24, 16, v24
    v_cvt_pk_bf16_f32 v25, v25, v25
    v_lshlrev_b32 v25, 16, v25
    v_cvt_pk_bf16_f32 v26, v26, v26
    v_lshlrev_b32 v26, 16, v26
    v_cvt_pk_bf16_f32 v27, v27, v27
    v_lshlrev_b32 v27, 16, v27
    v_cvt_pk_bf16_f32 v28, v28, v28
    v_lshlrev_b32 v28, 16, v28
    v_cvt_pk_bf16_f32 v29, v29, v29
    v_lshlrev_b32 v29, 16, v29
    v_cvt_pk_bf16_f32 v30, v30, v30
    v_lshlrev_b32 v30, 16, v30
    v_cvt_pk_bf16_f32 v31, v31, v31
    v_lshlrev_b32 v31, 16, v31
    v_rcp_f32 v40, v24
    v_rcp_f32 v41, v25
    v_rcp_f32 v42, v26
    v_rcp_f32 v43, v27
    v_rcp_f32 v44, v28
    v_rcp_f32 v45, v29
    v_rcp_f32 v46, v30
    v_rcp_f32 v47, v31
    s_nop 0
    v_mov_b32 v104, v32
    v_mov_b32 v105, v40
    v_mov_b32 v106, v33
    v_mov_b32 v107, v41
    v_mov_b32 v108, v34
    v_mov_b32 v109, v42
    v_mov_b32 v110, v35
    v_mov_b32 v111, v43
    v_mov_b32 v112, v36
    v_mov_b32 v113, v44
    v_mov_b32 v114, v37
    v_mov_b32 v115, v45
    v_mov_b32 v116, v38
    v_mov_b32 v117, v46
    v_mov_b32 v118, v39
    v_mov_b32 v119, v47
    v_lshlrev_b32 v5, 3, v4
    s_mov_b32 s15, 45088768
    v_cmp_eq_u32 vcc, 0, v1
    s_and_saveexec_b64 s[16:17], vcc
    buffer_store_dwordx4 v[104:107], v5, s[8:11], s15 offen offset:0
    buffer_store_dwordx4 v[108:111], v5, s[8:11], s15 offen offset:16
    buffer_store_dwordx4 v[112:115], v5, s[8:11], s15 offen offset:32
    buffer_store_dwordx4 v[116:119], v5, s[8:11], s15 offen offset:48
    s_endpgm
prep_kernel_end:
    s_endpgm
.globl conv_kernel
.p2align 8
.type conv_kernel,@function
conv_kernel:
    s_cmp_ge_u32 s2, 640
    s_cbranch_scc1 conv_kernel_end
    s_load_dwordx2 s[4:5], s[0:1], 104
    s_load_dwordx2 s[8:9], s[0:1], 48
    v_lshrrev_b32 v2, 6, v0
    v_and_b32 v0, 63, v0
    v_lshlrev_b32 v1, 4, v0
    v_readfirstlane_b32 s22, v2
    s_lshl_b32 s12, s2, 12
    s_waitcnt lgkmcnt(0)
    s_and_b32 s5, s5, 0xffff
    s_mov_b32 s6, 268435456
    s_mov_b32 s7, 0x00020000
    s_and_b32 s9, s9, 0xffff
    s_mov_b32 s10, 1280
    s_mov_b32 s11, 0x00020000
    s_add_u32 s13, s12, 0
    s_add_u32 s14, s12, 36700160
    buffer_load_dwordx4 v[32:35], v1, s[4:7], s14 offen offset:0
    buffer_load_dwordx4 v[36:39], v1, s[4:7], s14 offen offset:16
    buffer_load_dwordx4 v[40:43], v1, s[4:7], s14 offen offset:1024
    buffer_load_dwordx4 v[44:47], v1, s[4:7], s14 offen offset:1040
    buffer_load_dwordx4 v[48:51], v1, s[4:7], s14 offen offset:2048
    buffer_load_dwordx4 v[52:55], v1, s[4:7], s14 offen offset:2064
    buffer_load_dwordx4 v[56:59], v1, s[4:7], s14 offen offset:3072
    buffer_load_dwordx4 v[60:63], v1, s[4:7], s14 offen offset:3088
    v_and_b32 v11, 31, v0
    v_lshrrev_b32 v12, 5, v0
    v_mov_b32 v64, 0
    v_mov_b32 v65, 0
    v_mov_b32 v66, 0
    v_mov_b32 v67, 0
    s_lshl_b32 s15, s2, 1
    v_mov_b32 v2, s15
    buffer_load_ushort v15, v2, s[8:11], 0 offen
    v_lshlrev_b32 v112, 6, v11
    v_lshl_add_u32 v112, v12, 3, v112
    s_min_u32 s23, s22, 1
    s_lshl_b32 s24, s23, 11
    s_add_u32 s16, s12, 3145728
    s_add_u32 s16, s16, s24
    s_mul_i32 s17, s2, 4224
    s_add_u32 s17, s17, 39845888
    s_add_u32 s17, s17, s24
    buffer_load_dwordx2 v[116:117], v112, s[4:7], s16 offen offset:0
    buffer_load_dwordx2 v[118:119], v112, s[4:7], s16 offen offset:16
    buffer_load_dwordx2 v[120:121], v112, s[4:7], s16 offen offset:32
    buffer_load_dwordx2 v[122:123], v112, s[4:7], s16 offen offset:48
    s_cmp_eq_u32 s22, 1
    s_cbranch_scc1 conv_kernel_w1
    s_cmp_eq_u32 s22, 2
    s_cbranch_scc1 conv_kernel_w2
    s_add_u32 s13, s12, 3145728
    v_lshlrev_b32 v7, 6, v0
    buffer_load_dwordx4 v[16:19], v1, s[4:7], s13 offen offset:0
    s_mov_b32 s26, 45088768
    buffer_load_dwordx4 v[80:83], v7, s[4:7], s26 offen offset:0
    buffer_load_dwordx4 v[84:87], v7, s[4:7], s26 offen offset:16
    buffer_load_dwordx4 v[88:91], v7, s[4:7], s26 offen offset:32
    buffer_load_dwordx4 v[92:95], v7, s[4:7], s26 offen offset:48
    buffer_load_dwordx4 v[20:23], v1, s[4:7], s13 offen offset:1024
    s_mov_b32 s26, 45092864
    buffer_load_dwordx4 v[96:99], v7, s[4:7], s26 offen offset:0
    buffer_load_dwordx4 v[100:103], v7, s[4:7], s26 offen offset:16
    buffer_load_dwordx4 v[104:107], v7, s[4:7], s26 offen offset:32
    buffer_load_dwordx4 v[108:111], v7, s[4:7], s26 offen offset:48
    v_lshrrev_b32 v3, 2, v0
    v_mul_u32_u24 v3, 4160, v3
    v_and_b32 v4, 3, v0
    v_lshl_add_u32 v3, v4, 4, v3
    v_cmp_gt_u32 vcc, 8, v0
    s_and_saveexec_b64 s[20:21], vcc
    ds_write_b128 v3, v[64:67] offset:14336
    s_mov_b64 exec, s[20:21]
    s_waitcnt vmcnt(10)
    v_cmp_eq_u32 vcc, 63, v0
    s_nop 1
    v_cndmask_b32 v60, v60, v64, vcc
    v_cndmask_b32 v61, v61, v64, vcc
    v_cndmask_b32 v62, v62, v64, vcc
    v_cndmask_b32 v63, v63, v64, vcc
    v_alignbit_b32 v72, v36, v35, 16
    v_alignbit_b32 v73, v37, v36, 16
    v_alignbit_b32 v74, v38, v37, 16
    v_alignbit_b32 v75, v39, v38, 16
    ds_write_b128 v1, v[72:75] offset:10240
    v_mov_b32 v68, v35
    v_mov_b32 v69, v36
    v_mov_b32 v70, v37
    v_mov_b32 v71, v38
    ds_write_b128 v1, v[68:71] offset:14400
    v_alignbit_b32 v72, v44, v43, 16
    v_alignbit_b32 v73, v45, v44, 16
    v_alignbit_b32 v74, v46, v45, 16
    v_alignbit_b32 v75, v47, v46, 16
    ds_write_b128 v1, v[72:75] offset:11264
    v_mov_b32 v68, v43
    v_mov_b32 v69, v44
    v_mov_b32 v70, v45
    v_mov_b32 v71, v46
    ds_write_b128 v1, v[68:71] offset:15424
    v_alignbit_b32 v72, v52, v51, 16
    v_alignbit_b32 v73, v53, v52, 16
    v_alignbit_b32 v74, v54, v53, 16
    v_alignbit_b32 v75, v55, v54, 16
    ds_write_b128 v1, v[72:75] offset:12288
    v_mov_b32 v68, v51
    v_mov_b32 v69, v52
    v_mov_b32 v70, v53
    v_mov_b32 v71, v54
    ds_write_b128 v1, v[68:71] offset:16448
    v_alignbit_b32 v72, v60, v59, 16
    v_alignbit_b32 v73, v61, v60, 16
    v_alignbit_b32 v74, v62, v61, 16
    v_alignbit_b32 v75, v63, v62, 16
    ds_write_b128 v1, v[72:75] offset:13312
    v_mov_b32 v68, v59
    v_mov_b32 v69, v60
    v_mov_b32 v70, v61
    v_mov_b32 v71, v62
    ds_write_b128 v1, v[68:71] offset:17472
    v_lshrrev_b32 v5, 2, v0
    v_mul_u32_u24 v5, 80, v5
    v_and_b32 v6, 3, v0
    v_lshl_add_u32 v5, v6, 4, v5
    s_mov_b32 s19, 0xffff0000
    s_waitcnt vmcnt(0)
    v_lshlrev_b32 v8, 16, v16
    v_and_b32 v9, s19, v16
    v_sub_f32 v8, v8, v80
    v_sub_f32 v9, v9, v82
    v_cvt_pk_bf16_f32 v8, v8, v9
    v_and_b32 v9, s19, v8
    v_lshlrev_b32 v8, 16, v8
    v_mul_f32 v8, v8, v81
    v_mul_f32 v9, v9, v83
    v_cvt_pk_bf16_f32 v16, v8, v9
    v_lshlrev_b32 v8, 16, v17
    v_and_b32 v9, s19, v17
    v_sub_f32 v8, v8, v84
    v_sub_f32 v9, v9, v86
    v_cvt_pk_bf16_f32 v8, v8, v9
    v_and_b32 v9, s19, v8
    v_lshlrev_b32 v8, 16, v8
    v_mul_f32 v8, v8, v85
    v_mul_f32 v9, v9, v87
    v_cvt_pk_bf16_f32 v17, v8, v9
    v_lshlrev_b32 v8, 16, v18
    v_and_b32 v9, s19, v18
    v_sub_f32 v8, v8, v88
    v_sub_f32 v9, v9, v90
    v_cvt_pk_bf16_f32 v8, v8, v9
    v_and_b32 v9, s19, v8
    v_lshlrev_b32 v8, 16, v8
    v_mul_f32 v8, v8, v89
    v_mul_f32 v9, v9, v91
    v_cvt_pk_bf16_f32 v18, v8, v9
    v_lshlrev_b32 v8, 16, v19
    v_and_b32 v9, s19, v19
    v_sub_f32 v8, v8, v92
    v_sub_f32 v9, v9, v94
    v_cvt_pk_bf16_f32 v8, v8, v9
    v_and_b32 v9, s19, v8
    v_lshlrev_b32 v8, 16, v8
    v_mul_f32 v8, v8, v93
    v_mul_f32 v9, v9, v95
    v_cvt_pk_bf16_f32 v19, v8, v9
    ds_write_b128 v5, v[16:19] offset:5120
    v_lshlrev_b32 v8, 16, v20
    v_and_b32 v9, s19, v20
    v_sub_f32 v8, v8, v96
    v_sub_f32 v9, v9, v98
    v_cvt_pk_bf16_f32 v8, v8, v9
    v_and_b32 v9, s19, v8
    v_lshlrev_b32 v8, 16, v8
    v_mul_f32 v8, v8, v97
    v_mul_f32 v9, v9, v99
    v_cvt_pk_bf16_f32 v20, v8, v9
    v_lshlrev_b32 v8, 16, v21
    v_and_b32 v9, s19, v21
    v_sub_f32 v8, v8, v100
    v_sub_f32 v9, v9, v102
    v_cvt_pk_bf16_f32 v8, v8, v9
    v_and_b32 v9, s19, v8
    v_lshlrev_b32 v8, 16, v8
    v_mul_f32 v8, v8, v101
    v_mul_f32 v9, v9, v103
    v_cvt_pk_bf16_f32 v21, v8, v9
    v_lshlrev_b32 v8, 16, v22
    v_and_b32 v9, s19, v22
    v_sub_f32 v8, v8, v104
    v_sub_f32 v9, v9, v106
    v_cvt_pk_bf16_f32 v8, v8, v9
    v_and_b32 v9, s19, v8
    v_lshlrev_b32 v8, 16, v8
    v_mul_f32 v8, v8, v105
    v_mul_f32 v9, v9, v107
    v_cvt_pk_bf16_f32 v22, v8, v9
    v_lshlrev_b32 v8, 16, v23
    v_and_b32 v9, s19, v23
    v_sub_f32 v8, v8, v108
    v_sub_f32 v9, v9, v110
    v_cvt_pk_bf16_f32 v8, v8, v9
    v_and_b32 v9, s19, v8
    v_lshlrev_b32 v8, 16, v8
    v_mul_f32 v8, v8, v109
    v_mul_f32 v9, v9, v111
    v_cvt_pk_bf16_f32 v23, v8, v9
    ds_write_b128 v5, v[20:23] offset:6400
    s_branch conv_kernel_main
conv_kernel_w1:
    s_add_u32 s13, s12, 3145728
    v_lshlrev_b32 v7, 6, v0
    buffer_load_dwordx4 v[16:19], v1, s[4:7], s13 offen offset:2048
    s_mov_b32 s26, 45096960
    buffer_load_dwordx4 v[80:83], v7, s[4:7], s26 offen offset:0
    buffer_load_dwordx4 v[84:87], v7, s[4:7], s26 offen offset:16
    buffer_load_dwordx4 v[88:91], v7, s[4:7], s26 offen offset:32
    buffer_load_dwordx4 v[92:95], v7, s[4:7], s26 offen offset:48
    ds_write_b128 v1, v[64:67] offset:0
    ds_write_b128 v1, v[64:67] offset:1024
    ds_write_b128 v1, v[64:67] offset:2048
    ds_write_b128 v1, v[64:67] offset:3072
    ds_write_b128 v1, v[64:67] offset:4096
    v_lshrrev_b32 v3, 2, v0
    v_mul_u32_u24 v3, 4160, v3
    v_and_b32 v4, 3, v0
    v_lshl_add_u32 v3, v4, 4, v3
    v_cmp_gt_u32 vcc, 12, v0
    s_and_saveexec_b64 s[20:21], vcc
    ds_write_b128 v3, v[64:67] offset:22656
    s_mov_b64 exec, s[20:21]
    s_waitcnt vmcnt(10)
    v_cmp_eq_u32 vcc, 63, v0
    s_nop 1
    v_cndmask_b32 v60, v60, v64, vcc
    v_cndmask_b32 v61, v61, v64, vcc
    v_cndmask_b32 v62, v62, v64, vcc
    v_cndmask_b32 v63, v63, v64, vcc
    v_alignbit_b32 v72, v35, v34, 16
    v_alignbit_b32 v73, v36, v35, 16
    v_alignbit_b32 v74, v37, v36, 16
    v_alignbit_b32 v75, v38, v37, 16
    ds_write_b128 v1, v[72:75] offset:18560
    ds_write_b128 v1, v[34:37] offset:22720
    v_alignbit_b32 v72, v34, v33, 16
    v_alignbit_b32 v73, v35, v34, 16
    v_alignbit_b32 v74, v36, v35, 16
    v_alignbit_b32 v75, v37, v36, 16
    ds_write_b128 v1, v[72:75] offset:26880
    v_alignbit_b32 v72, v43, v42, 16
    v_alignbit_b32 v73, v44, v43, 16
    v_alignbit_b32 v74, v45, v44, 16
    v_alignbit_b32 v75, v46, v45, 16
    ds_write_b128 v1, v[72:75] offset:19584
    ds_write_b128 v1, v[42:45] offset:23744
    v_alignbit_b32 v72, v42, v41, 16
    v_alignbit_b32 v73, v43, v42, 16
    v_alignbit_b32 v74, v44, v43, 16
    v_alignbit_b32 v75, v45, v44, 16
    ds_write_b128 v1, v[72:75] offset:27904
    v_alignbit_b32 v72, v51, v50, 16
    v_alignbit_b32 v73, v52, v51, 16
    v_alignbit_b32 v74, v53, v52, 16
    v_alignbit_b32 v75, v54, v53, 16
    ds_write_b128 v1, v[72:75] offset:20608
    ds_write_b128 v1, v[50:53] offset:24768
    v_alignbit_b32 v72, v50, v49, 16
    v_alignbit_b32 v73, v51, v50, 16
    v_alignbit_b32 v74, v52, v51, 16
    v_alignbit_b32 v75, v53, v52, 16
    ds_write_b128 v1, v[72:75] offset:28928
    v_alignbit_b32 v72, v59, v58, 16
    v_alignbit_b32 v73, v60, v59, 16
    v_alignbit_b32 v74, v61, v60, 16
    v_alignbit_b32 v75, v62, v61, 16
    ds_write_b128 v1, v[72:75] offset:21632
    ds_write_b128 v1, v[58:61] offset:25792
    v_alignbit_b32 v72, v58, v57, 16
    v_alignbit_b32 v73, v59, v58, 16
    v_alignbit_b32 v74, v60, v59, 16
    v_alignbit_b32 v75, v61, v60, 16
    ds_write_b128 v1, v[72:75] offset:29952
    v_lshrrev_b32 v5, 2, v0
    v_mul_u32_u24 v5, 80, v5
    v_and_b32 v6, 3, v0
    v_lshl_add_u32 v5, v6, 4, v5
    s_mov_b32 s19, 0xffff0000
    s_waitcnt vmcnt(0)
    v_lshlrev_b32 v8, 16, v16
    v_and_b32 v9, s19, v16
    v_sub_f32 v8, v8, v80
    v_sub_f32 v9, v9, v82
    v_cvt_pk_bf16_f32 v8, v8, v9
    v_and_b32 v9, s19, v8
    v_lshlrev_b32 v8, 16, v8
    v_mul_f32 v8, v8, v81
    v_mul_f32 v9, v9, v83
    v_cvt_pk_bf16_f32 v16, v8, v9
    v_lshlrev_b32 v8, 16, v17
    v_and_b32 v9, s19, v17
    v_sub_f32 v8, v8, v84
    v_sub_f32 v9, v9, v86
    v_cvt_pk_bf16_f32 v8, v8, v9
    v_and_b32 v9, s19, v8
    v_lshlrev_b32 v8, 16, v8
    v_mul_f32 v8, v8, v85
    v_mul_f32 v9, v9, v87
    v_cvt_pk_bf16_f32 v17, v8, v9
    v_lshlrev_b32 v8, 16, v18
    v_and_b32 v9, s19, v18
    v_sub_f32 v8, v8, v88
    v_sub_f32 v9, v9, v90
    v_cvt_pk_bf16_f32 v8, v8, v9
    v_and_b32 v9, s19, v8
    v_lshlrev_b32 v8, 16, v8
    v_mul_f32 v8, v8, v89
    v_mul_f32 v9, v9, v91
    v_cvt_pk_bf16_f32 v18, v8, v9
    v_lshlrev_b32 v8, 16, v19
    v_and_b32 v9, s19, v19
    v_sub_f32 v8, v8, v92
    v_sub_f32 v9, v9, v94
    v_cvt_pk_bf16_f32 v8, v8, v9
    v_and_b32 v9, s19, v8
    v_lshlrev_b32 v8, 16, v8
    v_mul_f32 v8, v8, v93
    v_mul_f32 v9, v9, v95
    v_cvt_pk_bf16_f32 v19, v8, v9
    ds_write_b128 v5, v[16:19] offset:7680
    s_branch conv_kernel_main
conv_kernel_w2:
    s_add_u32 s13, s12, 3145728
    v_lshlrev_b32 v7, 6, v0
    buffer_load_dwordx4 v[16:19], v1, s[4:7], s13 offen offset:3072
    s_mov_b32 s26, 45101056
    buffer_load_dwordx4 v[80:83], v7, s[4:7], s26 offen offset:0
    buffer_load_dwordx4 v[84:87], v7, s[4:7], s26 offen offset:16
    buffer_load_dwordx4 v[88:91], v7, s[4:7], s26 offen offset:32
    buffer_load_dwordx4 v[92:95], v7, s[4:7], s26 offen offset:48
    v_lshrrev_b32 v3, 2, v0
    v_mul_u32_u24 v3, 4160, v3
    v_and_b32 v4, 3, v0
    v_lshl_add_u32 v3, v4, 4, v3
    v_cmp_gt_u32 vcc, 12, v0
    s_and_saveexec_b64 s[20:21], vcc
    ds_write_b128 v3, v[64:67] offset:35136
    s_mov_b64 exec, s[20:21]
    s_waitcnt vmcnt(10)
    v_cmp_eq_u32 vcc, 63, v0
    s_nop 1
    v_cndmask_b32 v60, v60, v64, vcc
    v_cndmask_b32 v61, v61, v64, vcc
    v_cndmask_b32 v62, v62, v64, vcc
    v_cndmask_b32 v63, v63, v64, vcc
    v_mov_b32 v68, v33
    v_mov_b32 v69, v34
    v_mov_b32 v70, v35
    v_mov_b32 v71, v36
    ds_write_b128 v1, v[68:71] offset:31040
    v_alignbit_b32 v72, v33, v32, 16
    v_alignbit_b32 v73, v34, v33, 16
    v_alignbit_b32 v74, v35, v34, 16
    v_alignbit_b32 v75, v36, v35, 16
    ds_write_b128 v1, v[72:75] offset:35200
    ds_write_b128 v1, v[32:35] offset:39360
    v_mov_b32 v68, v41
    v_mov_b32 v69, v42
    v_mov_b32 v70, v43
    v_mov_b32 v71, v44
    ds_write_b128 v1, v[68:71] offset:32064
    v_alignbit_b32 v72, v41, v40, 16
    v_alignbit_b32 v73, v42, v41, 16
    v_alignbit_b32 v74, v43, v42, 16
    v_alignbit_b32 v75, v44, v43, 16
    ds_write_b128 v1, v[72:75] offset:36224
    ds_write_b128 v1, v[40:43] offset:40384
    v_mov_b32 v68, v49
    v_mov_b32 v69, v50
    v_mov_b32 v70, v51
    v_mov_b32 v71, v52
    ds_write_b128 v1, v[68:71] offset:33088
    v_alignbit_b32 v72, v49, v48, 16
    v_alignbit_b32 v73, v50, v49, 16
    v_alignbit_b32 v74, v51, v50, 16
    v_alignbit_b32 v75, v52, v51, 16
    ds_write_b128 v1, v[72:75] offset:37248
    ds_write_b128 v1, v[48:51] offset:41408
    v_mov_b32 v68, v57
    v_mov_b32 v69, v58
    v_mov_b32 v70, v59
    v_mov_b32 v71, v60
    ds_write_b128 v1, v[68:71] offset:34112
    v_alignbit_b32 v72, v57, v56, 16
    v_alignbit_b32 v73, v58, v57, 16
    v_alignbit_b32 v74, v59, v58, 16
    v_alignbit_b32 v75, v60, v59, 16
    ds_write_b128 v1, v[72:75] offset:38272
    ds_write_b128 v1, v[56:59] offset:42432
    v_lshrrev_b32 v5, 2, v0
    v_mul_u32_u24 v5, 80, v5
    v_and_b32 v6, 3, v0
    v_lshl_add_u32 v5, v6, 4, v5
    s_mov_b32 s19, 0xffff0000
    s_waitcnt vmcnt(0)
    v_lshlrev_b32 v8, 16, v16
    v_and_b32 v9, s19, v16
    v_sub_f32 v8, v8, v80
    v_sub_f32 v9, v9, v82
    v_cvt_pk_bf16_f32 v8, v8, v9
    v_and_b32 v9, s19, v8
    v_lshlrev_b32 v8, 16, v8
    v_mul_f32 v8, v8, v81
    v_mul_f32 v9, v9, v83
    v_cvt_pk_bf16_f32 v16, v8, v9
    v_lshlrev_b32 v8, 16, v17
    v_and_b32 v9, s19, v17
    v_sub_f32 v8, v8, v84
    v_sub_f32 v9, v9, v86
    v_cvt_pk_bf16_f32 v8, v8, v9
    v_and_b32 v9, s19, v8
    v_lshlrev_b32 v8, 16, v8
    v_mul_f32 v8, v8, v85
    v_mul_f32 v9, v9, v87
    v_cvt_pk_bf16_f32 v17, v8, v9
    v_lshlrev_b32 v8, 16, v18
    v_and_b32 v9, s19, v18
    v_sub_f32 v8, v8, v88
    v_sub_f32 v9, v9, v90
    v_cvt_pk_bf16_f32 v8, v8, v9
    v_and_b32 v9, s19, v8
    v_lshlrev_b32 v8, 16, v8
    v_mul_f32 v8, v8, v89
    v_mul_f32 v9, v9, v91
    v_cvt_pk_bf16_f32 v18, v8, v9
    v_lshlrev_b32 v8, 16, v19
    v_and_b32 v9, s19, v19
    v_sub_f32 v8, v8, v92
    v_sub_f32 v9, v9, v94
    v_cvt_pk_bf16_f32 v8, v8, v9
    v_and_b32 v9, s19, v8
    v_lshlrev_b32 v8, 16, v8
    v_mul_f32 v8, v8, v93
    v_mul_f32 v9, v9, v95
    v_cvt_pk_bf16_f32 v19, v8, v9
    ds_write_b128 v5, v[16:19] offset:8960
conv_kernel_main:
    v_and_b32 v3, 7, v11
    v_mul_u32_u24 v13, 4160, v3
    v_lshrrev_b32 v3, 3, v11
    v_sub_u32 v3, v12, v3
    v_lshl_add_u32 v13, v3, 4, v13
    v_add_u32 v13, 13872, v13
    v_mul_u32_u24 v14, 80, v11
    v_lshl_add_u32 v14, v12, 4, v14
    s_mul_i32 s24, s23, 2560
    v_add_u32 v113, 5120, v14
    v_add_u32 v113, s24, v113
    v_lshlrev_b32 v3, 3, v12
    v_sub_u32 v113, v113, v3
    v_add_u32 v14, 4560, v14
    v_add_u32 v14, s24, v14
    s_cmp_eq_u32 s22, 2
    s_cselect_b32 s24, 2048, 0
    s_cselect_b32 s25, 2560, 0
    v_subrev_u32 v13, s24, v13
    v_subrev_u32 v14, s25, v14
    v_mov_b32 v80, 0
    v_mov_b32 v81, 0
    v_mov_b32 v82, 0
    v_mov_b32 v83, 0
    v_mov_b32 v84, 0
    v_mov_b32 v85, 0
    v_mov_b32 v86, 0
    v_mov_b32 v87, 0
    v_mov_b32 v88, 0
    v_mov_b32 v89, 0
    v_mov_b32 v90, 0
    v_mov_b32 v91, 0
    v_mov_b32 v92, 0
    v_mov_b32 v93, 0
    v_mov_b32 v94, 0
    v_mov_b32 v95, 0
    s_waitcnt lgkmcnt(0)
    s_barrier
    s_mov_b32 s18, 0
    ds_read_b128 v[16:19], v13 offset:448
    ds_read_b128 v[20:23], v13 offset:480
    ds_read_b128 v[24:27], v14 offset:560
    ds_read_b128 v[28:31], v14 offset:592
    ds_read_b128 v[32:35], v13 offset:384
    ds_read_b128 v[36:39], v13 offset:416
    ds_read_b128 v[40:43], v14 offset:480
    ds_read_b128 v[44:47], v14 offset:512
conv_kernel_loop:
    ds_read_b128 v[48:51], v13 offset:320
    ds_read_b128 v[52:55], v13 offset:352
    ds_read_b128 v[56:59], v14 offset:400
    ds_read_b128 v[60:63], v14 offset:432
    s_waitcnt lgkmcnt(8)
    v_mfma_f32_32x32x16_bf16 v[80:95], v[16:19], v[24:27], v[80:95]
    v_mfma_f32_32x32x16_bf16 v[80:95], v[20:23], v[28:31], v[80:95]
    ds_read_b128 v[64:67], v13 offset:256
    ds_read_b128 v[68:71], v13 offset:288
    ds_read_b128 v[72:75], v14 offset:320
    ds_read_b128 v[76:79], v14 offset:352
    s_waitcnt lgkmcnt(8)
    v_mfma_f32_32x32x16_bf16 v[80:95], v[32:35], v[40:43], v[80:95]
    v_mfma_f32_32x32x16_bf16 v[80:95], v[36:39], v[44:47], v[80:95]
    ds_read_b128 v[16:19], v13 offset:192
    ds_read_b128 v[20:23], v13 offset:224
    ds_read_b128 v[24:27], v14 offset:240
    ds_read_b128 v[28:31], v14 offset:272
    s_waitcnt lgkmcnt(8)
    v_mfma_f32_32x32x16_bf16 v[80:95], v[48:51], v[56:59], v[80:95]
    v_mfma_f32_32x32x16_bf16 v[80:95], v[52:55], v[60:63], v[80:95]
    ds_read_b128 v[32:35], v13 offset:128
    ds_read_b128 v[36:39], v13 offset:160
    ds_read_b128 v[40:43], v14 offset:160
    ds_read_b128 v[44:47], v14 offset:192
    s_waitcnt lgkmcnt(8)
    v_mfma_f32_32x32x16_bf16 v[80:95], v[64:67], v[72:75], v[80:95]
    v_mfma_f32_32x32x16_bf16 v[80:95], v[68:71], v[76:79], v[80:95]
    ds_read_b128 v[48:51], v13 offset:64
    ds_read_b128 v[52:55], v13 offset:96
    ds_read_b128 v[56:59], v14 offset:80
    ds_read_b128 v[60:63], v14 offset:112
    s_waitcnt lgkmcnt(8)
    v_mfma_f32_32x32x16_bf16 v[80:95], v[16:19], v[24:27], v[80:95]
    v_mfma_f32_32x32x16_bf16 v[80:95], v[20:23], v[28:31], v[80:95]
    ds_read_b128 v[64:67], v13 offset:0
    ds_read_b128 v[68:71], v13 offset:32
    ds_read_b128 v[72:75], v14 offset:0
    ds_read_b128 v[76:79], v14 offset:32
    s_waitcnt lgkmcnt(8)
    v_mfma_f32_32x32x16_bf16 v[80:95], v[32:35], v[40:43], v[80:95]
    v_mfma_f32_32x32x16_bf16 v[80:95], v[36:39], v[44:47], v[80:95]
    v_subrev_u32 v13, 512, v13
    v_subrev_u32 v14, 640, v14
    v_max_i32 v13, 0, v13
    v_max_i32 v14, 0, v14
    ds_read_b128 v[16:19], v13 offset:448
    ds_read_b128 v[20:23], v13 offset:480
    ds_read_b128 v[24:27], v14 offset:560
    ds_read_b128 v[28:31], v14 offset:592
    s_waitcnt lgkmcnt(8)
    v_mfma_f32_32x32x16_bf16 v[80:95], v[48:51], v[56:59], v[80:95]
    v_mfma_f32_32x32x16_bf16 v[80:95], v[52:55], v[60:63], v[80:95]
    ds_read_b128 v[32:35], v13 offset:384
    ds_read_b128 v[36:39], v13 offset:416
    ds_read_b128 v[40:43], v14 offset:480
    ds_read_b128 v[44:47], v14 offset:512
    s_waitcnt lgkmcnt(8)
    v_mfma_f32_32x32x16_bf16 v[80:95], v[64:67], v[72:75], v[80:95]
    v_mfma_f32_32x32x16_bf16 v[80:95], v[68:71], v[76:79], v[80:95]
    s_add_u32 s18, s18, 1
    s_cmp_lt_u32 s18, 4
    s_cbranch_scc1 conv_kernel_loop
    s_waitcnt lgkmcnt(0)
    s_nop 7
    s_nop 3
    s_cmp_lg_u32 s22, 2
    s_cbranch_scc1 conv_kernel_nb
    ds_write_b128 v1, v[80:83] offset:43520
    ds_write_b128 v1, v[84:87] offset:44544
    ds_write_b128 v1, v[88:91] offset:45568
    ds_write_b128 v1, v[92:95] offset:46592
    s_waitcnt lgkmcnt(0)
    s_barrier
    s_endpgm
conv_kernel_nb:
    s_barrier
    s_cmp_lg_u32 s22, 1
    s_cbranch_scc1 conv_kernel_ep
    ds_read_b128 v[16:19], v1 offset:43520
    ds_read_b128 v[20:23], v1 offset:44544
    ds_read_b128 v[24:27], v1 offset:45568
    ds_read_b128 v[28:31], v1 offset:46592
    s_waitcnt lgkmcnt(0)
    v_add_f32 v80, v80, v16
    v_add_f32 v81, v81, v17
    v_add_f32 v82, v82, v18
    v_add_f32 v83, v83, v19
    v_add_f32 v84, v84, v20
    v_add_f32 v85, v85, v21
    v_add_f32 v86, v86, v22
    v_add_f32 v87, v87, v23
    v_add_f32 v88, v88, v24
    v_add_f32 v89, v89, v25
    v_add_f32 v90, v90, v26
    v_add_f32 v91, v91, v27
    v_add_f32 v92, v92, v28
    v_add_f32 v93, v93, v29
    v_add_f32 v94, v94, v30
    v_add_f32 v95, v95, v31
conv_kernel_ep:
    v_lshlrev_b32 v15, 16, v15
    s_mov_b32 s19, 0xffff0000
    ds_read_b64 v[18:19], v113 offset:0
    ds_read_b64 v[20:21], v113 offset:16
    ds_read_b64 v[22:23], v113 offset:32
    ds_read_b64 v[24:25], v113 offset:48
    s_waitcnt vmcnt(0) lgkmcnt(0)
    v_lshlrev_b32 v40, 16, v18
    v_and_b32 v41, s19, v18
    v_mul_f32 v40, v40, v15
    v_mul_f32 v41, v41, v15
    v_cvt_pk_bf16_f32 v40, v40, v41
    v_cvt_pk_bf16_f32 v42, v80, v81
    v_lshlrev_b32 v41, 16, v40
    v_and_b32 v40, s19, v40
    v_lshlrev_b32 v43, 16, v42
    v_and_b32 v42, s19, v42
    v_add_f32 v41, v41, v43
    v_add_f32 v40, v40, v42
    v_cvt_pk_bf16_f32 v42, v41, v40
    v_lshlrev_b32 v41, 16, v116
    v_and_b32 v40, s19, v116
    v_lshlrev_b32 v43, 16, v42
    v_and_b32 v42, s19, v42
    v_add_f32 v41, v41, v43
    v_add_f32 v40, v40, v42
    v_cvt_pk_bf16_f32 v116, v41, v40
    v_lshlrev_b32 v40, 16, v19
    v_and_b32 v41, s19, v19
    v_mul_f32 v40, v40, v15
    v_mul_f32 v41, v41, v15
    v_cvt_pk_bf16_f32 v40, v40, v41
    v_cvt_pk_bf16_f32 v42, v82, v83
    v_lshlrev_b32 v41, 16, v40
    v_and_b32 v40, s19, v40
    v_lshlrev_b32 v43, 16, v42
    v_and_b32 v42, s19, v42
    v_add_f32 v41, v41, v43
    v_add_f32 v40, v40, v42
    v_cvt_pk_bf16_f32 v42, v41, v40
    v_lshlrev_b32 v41, 16, v117
    v_and_b32 v40, s19, v117
    v_lshlrev_b32 v43, 16, v42
    v_and_b32 v42, s19, v42
    v_add_f32 v41, v41, v43
    v_add_f32 v40, v40, v42
    v_cvt_pk_bf16_f32 v117, v41, v40
    buffer_store_dwordx2 v[116:117], v112, s[4:7], s17 offen offset:0
    v_lshlrev_b32 v40, 16, v20
    v_and_b32 v41, s19, v20
    v_mul_f32 v40, v40, v15
    v_mul_f32 v41, v41, v15
    v_cvt_pk_bf16_f32 v40, v40, v41
    v_cvt_pk_bf16_f32 v42, v84, v85
    v_lshlrev_b32 v41, 16, v40
    v_and_b32 v40, s19, v40
    v_lshlrev_b32 v43, 16, v42
    v_and_b32 v42, s19, v42
    v_add_f32 v41, v41, v43
    v_add_f32 v40, v40, v42
    v_cvt_pk_bf16_f32 v42, v41, v40
    v_lshlrev_b32 v41, 16, v118
    v_and_b32 v40, s19, v118
    v_lshlrev_b32 v43, 16, v42
    v_and_b32 v42, s19, v42
    v_add_f32 v41, v41, v43
    v_add_f32 v40, v40, v42
    v_cvt_pk_bf16_f32 v118, v41, v40
    v_lshlrev_b32 v40, 16, v21
    v_and_b32 v41, s19, v21
    v_mul_f32 v40, v40, v15
    v_mul_f32 v41, v41, v15
    v_cvt_pk_bf16_f32 v40, v40, v41
    v_cvt_pk_bf16_f32 v42, v86, v87
    v_lshlrev_b32 v41, 16, v40
    v_and_b32 v40, s19, v40
    v_lshlrev_b32 v43, 16, v42
    v_and_b32 v42, s19, v42
    v_add_f32 v41, v41, v43
    v_add_f32 v40, v40, v42
    v_cvt_pk_bf16_f32 v42, v41, v40
    v_lshlrev_b32 v41, 16, v119
    v_and_b32 v40, s19, v119
    v_lshlrev_b32 v43, 16, v42
    v_and_b32 v42, s19, v42
    v_add_f32 v41, v41, v43
    v_add_f32 v40, v40, v42
    v_cvt_pk_bf16_f32 v119, v41, v40
    buffer_store_dwordx2 v[118:119], v112, s[4:7], s17 offen offset:16
    v_lshlrev_b32 v40, 16, v22
    v_and_b32 v41, s19, v22
    v_mul_f32 v40, v40, v15
    v_mul_f32 v41, v41, v15
    v_cvt_pk_bf16_f32 v40, v40, v41
    v_cvt_pk_bf16_f32 v42, v88, v89
    v_lshlrev_b32 v41, 16, v40
    v_and_b32 v40, s19, v40
    v_lshlrev_b32 v43, 16, v42
    v_and_b32 v42, s19, v42
    v_add_f32 v41, v41, v43
    v_add_f32 v40, v40, v42
    v_cvt_pk_bf16_f32 v42, v41, v40
    v_lshlrev_b32 v41, 16, v120
    v_and_b32 v40, s19, v120
    v_lshlrev_b32 v43, 16, v42
    v_and_b32 v42, s19, v42
    v_add_f32 v41, v41, v43
    v_add_f32 v40, v40, v42
    v_cvt_pk_bf16_f32 v120, v41, v40
    v_lshlrev_b32 v40, 16, v23
    v_and_b32 v41, s19, v23
    v_mul_f32 v40, v40, v15
    v_mul_f32 v41, v41, v15
    v_cvt_pk_bf16_f32 v40, v40, v41
    v_cvt_pk_bf16_f32 v42, v90, v91
    v_lshlrev_b32 v41, 16, v40
    v_and_b32 v40, s19, v40
    v_lshlrev_b32 v43, 16, v42
    v_and_b32 v42, s19, v42
    v_add_f32 v41, v41, v43
    v_add_f32 v40, v40, v42
    v_cvt_pk_bf16_f32 v42, v41, v40
    v_lshlrev_b32 v41, 16, v121
    v_and_b32 v40, s19, v121
    v_lshlrev_b32 v43, 16, v42
    v_and_b32 v42, s19, v42
    v_add_f32 v41, v41, v43
    v_add_f32 v40, v40, v42
    v_cvt_pk_bf16_f32 v121, v41, v40
    buffer_store_dwordx2 v[120:121], v112, s[4:7], s17 offen offset:32
    v_lshlrev_b32 v40, 16, v24
    v_and_b32 v41, s19, v24
    v_mul_f32 v40, v40, v15
    v_mul_f32 v41, v41, v15
    v_cvt_pk_bf16_f32 v40, v40, v41
    v_cvt_pk_bf16_f32 v42, v92, v93
    v_lshlrev_b32 v41, 16, v40
    v_and_b32 v40, s19, v40
    v_lshlrev_b32 v43, 16, v42
    v_and_b32 v42, s19, v42
    v_add_f32 v41, v41, v43
    v_add_f32 v40, v40, v42
    v_cvt_pk_bf16_f32 v42, v41, v40
    v_lshlrev_b32 v41, 16, v122
    v_and_b32 v40, s19, v122
    v_lshlrev_b32 v43, 16, v42
    v_and_b32 v42, s19, v42
    v_add_f32 v41, v41, v43
    v_add_f32 v40, v40, v42
    v_cvt_pk_bf16_f32 v122, v41, v40
    v_lshlrev_b32 v40, 16, v25
    v_and_b32 v41, s19, v25
    v_mul_f32 v40, v40, v15
    v_mul_f32 v41, v41, v15
    v_cvt_pk_bf16_f32 v40, v40, v41
    v_cvt_pk_bf16_f32 v42, v94, v95
    v_lshlrev_b32 v41, 16, v40
    v_and_b32 v40, s19, v40
    v_lshlrev_b32 v43, 16, v42
    v_and_b32 v42, s19, v42
    v_add_f32 v41, v41, v43
    v_add_f32 v40, v40, v42
    v_cvt_pk_bf16_f32 v42, v41, v40
    v_lshlrev_b32 v41, 16, v123
    v_and_b32 v40, s19, v123
    v_lshlrev_b32 v43, 16, v42
    v_and_b32 v42, s19, v42
    v_add_f32 v41, v41, v43
    v_add_f32 v40, v40, v42
    v_cvt_pk_bf16_f32 v123, v41, v40
    buffer_store_dwordx2 v[122:123], v112, s[4:7], s17 offen offset:48
conv_kernel_end:
    s_endpgm
.globl gemm1_kernel
.p2align 8
.type gemm1_kernel,@function
gemm1_kernel:
    s_cmp_ge_u32 s2, 464
    s_cbranch_scc1 gemm1_kernel_end
    s_load_dwordx2 s[4:5], s[0:1], 104
    s_load_dwordx2 s[44:45], s[0:1], 64
    s_load_dwordx2 s[48:49], s[0:1], 72
    s_load_dwordx2 s[52:53], s[0:1], 96
    s_cmp_lt_u32 s2, 32
    s_cbranch_scc1 gemm1_kernel_stats
    s_sub_u32 s2, s2, 32
    v_lshrrev_b32 v1, 6, v0
    v_and_b32 v2, 63, v0
    s_and_b32 s12, s2, 7
    s_mul_i32 s12, s12, 54
    s_lshr_b32 s13, s2, 3
    s_add_u32 s3, s12, s13
    s_and_b32 s12, s3, 15
    v_readfirstlane_b32 s14, v1
    s_lshr_b32 s13, s3, 4
    v_lshrrev_b32 v4, 4, v2
    v_and_b32 v4, 1, v4
    v_lshlrev_b32 v4, 2, v4
    v_and_b32 v5, 7, v2
    v_xor_b32 v19, v4, v5
    v_lshrrev_b32 v3, 3, v2
    v_mul_u32_u24 v4, 3456, v3
    v_lshl_add_u32 v8, v19, 4, v4
    v_add_u32 v9, 26624, v8
    v_mul_u32_u24 v4, 4224, v3
    v_lshl_add_u32 v6, v19, 4, v4
    v_add_u32 v7, 32768, v6
    s_waitcnt lgkmcnt(0)
    s_and_b32 s5, s5, 0xffff
    s_mov_b32 s6, 268435456
    s_mov_b32 s7, 0x00020000
    s_and_b32 s45, s45, 0xffff
    s_mov_b32 s46, 2211840
    s_mov_b32 s47, 0x00020000
    s_and_b32 s49, s49, 0xffff
    s_mov_b32 s50, 2211840
    s_mov_b32 s51, 0x00020000
    s_and_b32 s53, s53, 0xffff
    s_mov_b32 s54, 256
    s_mov_b32 s55, 0x00020000
    s_lshr_b32 s17, s14, 1
    s_and_b32 s18, s14, 1
    s_lshl_b32 s16, s12, 8
    s_lshl_b32 s15, s17, 7
    s_add_u32 s16, s16, s15
    s_mul_i32 s15, s18, 67584
    s_add_u32 s16, s16, s15
    s_add_u32 s16, s16, 39845888
    s_cmp_eq_u32 s17, 0
    s_cselect_b32 s44, s44, s48
    s_cselect_b32 s45, s45, s49
    s_mul_i32 s17, s18, 55296
    s_lshl_b32 s15, s13, 7
    s_add_u32 s17, s17, s15
    s_lshl_b32 s19, s14, 11
    s_add_u32 s20, s19, 8192
    s_add_u32 m0, s19, 0
    s_nop 0
    buffer_load_dwordx4 v6, s[4:7], s16 offen offset:0 lds
    buffer_load_dwordx4 v7, s[4:7], s16 offen offset:1024 lds
    s_add_u32 m0, s20, 0
    s_add_u32 s16, s16, 135168
    buffer_load_dwordx4 v8, s[44:47], s17 offen offset:0 lds
    buffer_load_dwordx4 v9, s[44:47], s17 offen offset:1024 lds
    s_add_u32 s17, s17, 110592
    s_add_u32 m0, s19, 16384
    s_nop 0
    buffer_load_dwordx4 v6, s[4:7], s16 offen offset:0 lds
    buffer_load_dwordx4 v7, s[4:7], s16 offen offset:1024 lds
    s_add_u32 m0, s20, 16384
    s_add_u32 s16, s16, 135168
    buffer_load_dwordx4 v8, s[44:47], s17 offen offset:0 lds
    buffer_load_dwordx4 v9, s[44:47], s17 offen offset:1024 lds
    s_add_u32 s17, s17, 110592
    s_add_u32 m0, s19, 32768
    s_nop 0
    buffer_load_dwordx4 v6, s[4:7], s16 offen offset:0 lds
    buffer_load_dwordx4 v7, s[4:7], s16 offen offset:1024 lds
    s_add_u32 m0, s20, 32768
    s_add_u32 s16, s16, 135168
    buffer_load_dwordx4 v8, s[44:47], s17 offen offset:0 lds
    buffer_load_dwordx4 v9, s[44:47], s17 offen offset:1024 lds
    s_add_u32 s17, s17, 110592
    v_and_b32 v10, 31, v2
    v_lshrrev_b32 v11, 5, v2
    v_and_b32 v12, 1, v1
    v_lshrrev_b32 v13, 1, v1
    v_and_b32 v14, 15, v2
    v_lshrrev_b32 v14, 2, v14
    v_lshl_add_u32 v14, v11, 3, v14
    v_lshlrev_b32 v14, 7, v14
    v_lshrrev_b32 v3, 4, v2
    v_and_b32 v3, 1, v3
    v_lshlrev_b32 v3, 1, v3
    v_and_b32 v4, 3, v2
    v_lshrrev_b32 v4, 1, v4
    v_add_u32 v3, v3, v4
    v_lshrrev_b32 v4, 3, v2
    v_and_b32 v4, 1, v4
    v_lshlrev_b32 v4, 2, v4
    v_xor_b32 v3, v3, v4
    v_lshl_add_u32 v14, v3, 4, v14
    v_and_b32 v4, 1, v2
    v_lshl_add_u32 v14, v4, 3, v14
    v_lshlrev_b32 v3, 6, v13
    v_xor_b32 v22, v3, v14
    v_add_u32 v22, 8192, v22
    v_lshl_add_u32 v20, v12, 12, v14
    v_xor_b32 v21, 64, v20
    v_add_u32 v232, 0x10000, v20
    v_add_u32 v233, 0x10000, v21
    v_add_u32 v234, 0x10000, v22
    v_mov_b32 v56, 0
    v_mov_b32 v57, 0
    v_mov_b32 v58, 0
    v_mov_b32 v59, 0
    v_mov_b32 v60, 0
    v_mov_b32 v61, 0
    v_mov_b32 v62, 0
    v_mov_b32 v63, 0
    v_mov_b32 v64, 0
    v_mov_b32 v65, 0
    v_mov_b32 v66, 0
    v_mov_b32 v67, 0
    v_mov_b32 v68, 0
    v_mov_b32 v69, 0
    v_mov_b32 v70, 0
    v_mov_b32 v71, 0
    v_mov_b32 v72, 0
    v_mov_b32 v73, 0
    v_mov_b32 v74, 0
    v_mov_b32 v75, 0
    v_mov_b32 v76, 0
    v_mov_b32 v77, 0
    v_mov_b32 v78, 0
    v_mov_b32 v79, 0
    v_mov_b32 v80, 0
    v_mov_b32 v81, 0
    v_mov_b32 v82, 0
    v_mov_b32 v83, 0
    v_mov_b32 v84, 0
    v_mov_b32 v85, 0
    v_mov_b32 v86, 0
    v_mov_b32 v87, 0
    v_mov_b32 v88, 0
    v_mov_b32 v89, 0
    v_mov_b32 v90, 0
    v_mov_b32 v91, 0
    v_mov_b32 v92, 0
    v_mov_b32 v93, 0
    v_mov_b32 v94, 0
    v_mov_b32 v95, 0
    v_mov_b32 v96, 0
    v_mov_b32 v97, 0
    v_mov_b32 v98, 0
    v_mov_b32 v99, 0
    v_mov_b32 v100, 0
    v_mov_b32 v101, 0
    v_mov_b32 v102, 0
    v_mov_b32 v103, 0
    v_mov_b32 v104, 0
    v_mov_b32 v105, 0
    v_mov_b32 v106, 0
    v_mov_b32 v107, 0
    v_mov_b32 v108, 0
    v_mov_b32 v109, 0
    v_mov_b32 v110, 0
    v_mov_b32 v111, 0
    v_mov_b32 v112, 0
    v_mov_b32 v113, 0
    v_mov_b32 v114, 0
    v_mov_b32 v115, 0
    v_mov_b32 v116, 0
    v_mov_b32 v117, 0
    v_mov_b32 v118, 0
    v_mov_b32 v119, 0
    v_mov_b32 v128, 0
    v_mov_b32 v129, 0
    v_mov_b32 v130, 0
    v_mov_b32 v131, 0
    v_mov_b32 v132, 0
    v_mov_b32 v133, 0
    v_mov_b32 v134, 0
    v_mov_b32 v135, 0
    v_mov_b32 v136, 0
    v_mov_b32 v137, 0
    v_mov_b32 v138, 0
    v_mov_b32 v139, 0
    v_mov_b32 v140, 0
    v_mov_b32 v141, 0
    v_mov_b32 v142, 0
    v_mov_b32 v143, 0
    v_mov_b32 v144, 0
    v_mov_b32 v145, 0
    v_mov_b32 v146, 0
    v_mov_b32 v147, 0
    v_mov_b32 v148, 0
    v_mov_b32 v149, 0
    v_mov_b32 v150, 0
    v_mov_b32 v151, 0
    v_mov_b32 v152, 0
    v_mov_b32 v153, 0
    v_mov_b32 v154, 0
    v_mov_b32 v155, 0
    v_mov_b32 v156, 0
    v_mov_b32 v157, 0
    v_mov_b32 v158, 0
    v_mov_b32 v159, 0
    v_mov_b32 v124, 0x3f803f80
    v_mov_b32 v125, 0x3f803f80
    v_mov_b32 v126, 0x3f803f80
    v_mov_b32 v127, 0x3f803f80
    s_lshl_b32 s22, s12, 7
    v_lshl_add_u32 v17, v12, 6, v10
    v_add_u32 v17, s22, v17
    s_lshl_b32 s22, s13, 6
    v_lshlrev_b32 v18, 5, v13
    v_lshl_add_u32 v18, v11, 2, v18
    v_add_u32 v18, s22, v18
    v_lshlrev_b32 v3, 2, v18
    s_mov_b32 s27, 42991616
    s_mov_b32 s28, 42998528
    buffer_load_dwordx4 v[160:163], v3, s[4:7], s27 offen offset:0
    buffer_load_dwordx4 v[164:167], v3, s[4:7], s27 offen offset:32
    buffer_load_dwordx4 v[168:171], v3, s[4:7], s27 offen offset:64
    buffer_load_dwordx4 v[172:175], v3, s[4:7], s27 offen offset:96
    buffer_load_dwordx4 v[176:179], v3, s[4:7], s28 offen offset:0
    buffer_load_dwordx4 v[180:183], v3, s[4:7], s28 offen offset:32
    buffer_load_dwordx4 v[184:187], v3, s[4:7], s28 offen offset:64
    buffer_load_dwordx4 v[188:191], v3, s[4:7], s28 offen offset:96
    s_lshr_b32 s31, s14, 1
    s_movk_i32 s26, 3456
    v_mul_lo_u32 v17, v17, s26
    v_lshl_add_u32 v17, v18, 1, v17
    s_waitcnt vmcnt(16)
    s_barrier
    ds_read_b64_tr_b16 v[24:25], v22 offset:0
    ds_read_b64_tr_b16 v[26:27], v22 offset:512
    ds_read_b64_tr_b16 v[28:29], v22 offset:4096
    ds_read_b64_tr_b16 v[30:31], v22 offset:4608
    ds_read_b64_tr_b16 v[32:33], v20 offset:0
    ds_read_b64_tr_b16 v[34:35], v20 offset:512
    ds_read_b64_tr_b16 v[36:37], v21 offset:0
    ds_read_b64_tr_b16 v[38:39], v21 offset:512
    ds_read_b64_tr_b16 v[40:41], v22 offset:2048
    ds_read_b64_tr_b16 v[42:43], v22 offset:2560
    ds_read_b64_tr_b16 v[44:45], v22 offset:6144
    ds_read_b64_tr_b16 v[46:47], v22 offset:6656
    ds_read_b64_tr_b16 v[48:49], v20 offset:2048
    ds_read_b64_tr_b16 v[50:51], v20 offset:2560
    ds_read_b64_tr_b16 v[52:53], v21 offset:2048
    ds_read_b64_tr_b16 v[54:55], v21 offset:2560
    s_waitcnt lgkmcnt(8)
    v_mfma_f32_32x32x16_bf16 v[56:71], v[24:27], v[32:35], v[56:71]
    v_mfma_f32_32x32x16_bf16 v[72:87], v[24:27], v[36:39], v[72:87]
    v_mfma_f32_32x32x16_bf16 v[88:103], v[28:31], v[32:35], v[88:103]
    v_mfma_f32_32x32x16_bf16 v[104:119], v[28:31], v[36:39], v[104:119]
    s_waitcnt vmcnt(4)
    s_barrier
    s_add_u32 m0, s19, 49152
    s_nop 0
    buffer_load_dwordx4 v6, s[4:7], s16 offen offset:0 lds
    buffer_load_dwordx4 v7, s[4:7], s16 offen offset:1024 lds
    s_add_u32 m0, s20, 49152
    s_add_u32 s16, s16, 135168
    buffer_load_dwordx4 v8, s[44:47], s17 offen offset:0 lds
    buffer_load_dwordx4 v9, s[44:47], s17 offen offset:1024 lds
    s_add_u32 s17, s17, 110592
    ds_read_b64_tr_b16 v[24:25], v22 offset:16384
    ds_read_b64_tr_b16 v[26:27], v22 offset:16896
    ds_read_b64_tr_b16 v[28:29], v22 offset:20480
    ds_read_b64_tr_b16 v[30:31], v22 offset:20992
    ds_read_b64_tr_b16 v[32:33], v20 offset:16384
    ds_read_b64_tr_b16 v[34:35], v20 offset:16896
    ds_read_b64_tr_b16 v[36:37], v21 offset:16384
    ds_read_b64_tr_b16 v[38:39], v21 offset:16896
    s_waitcnt lgkmcnt(8)
    v_mfma_f32_32x32x16_bf16 v[56:71], v[40:43], v[48:51], v[56:71]
    v_mfma_f32_32x32x16_bf16 v[72:87], v[40:43], v[52:55], v[72:87]
    v_mfma_f32_32x32x16_bf16 v[88:103], v[44:47], v[48:51], v[88:103]
    v_mfma_f32_32x32x16_bf16 v[104:119], v[44:47], v[52:55], v[104:119]
    ds_read_b64_tr_b16 v[40:41], v22 offset:18432
    ds_read_b64_tr_b16 v[42:43], v22 offset:18944
    ds_read_b64_tr_b16 v[44:45], v22 offset:22528
    ds_read_b64_tr_b16 v[46:47], v22 offset:23040
    ds_read_b64_tr_b16 v[48:49], v20 offset:18432
    ds_read_b64_tr_b16 v[50:51], v20 offset:18944
    ds_read_b64_tr_b16 v[52:53], v21 offset:18432
    ds_read_b64_tr_b16 v[54:55], v21 offset:18944
    s_waitcnt lgkmcnt(8)
    v_mfma_f32_32x32x16_bf16 v[56:71], v[24:27], v[32:35], v[56:71]
    v_mfma_f32_32x32x16_bf16 v[72:87], v[24:27], v[36:39], v[72:87]
    v_mfma_f32_32x32x16_bf16 v[88:103], v[28:31], v[32:35], v[88:103]
    v_mfma_f32_32x32x16_bf16 v[104:119], v[28:31], v[36:39], v[104:119]
    s_waitcnt vmcnt(4)
    s_barrier
    s_add_u32 m0, s19, 0
    s_nop 0
    buffer_load_dwordx4 v6, s[4:7], s16 offen offset:0 lds
    buffer_load_dwordx4 v7, s[4:7], s16 offen offset:1024 lds
    s_add_u32 m0, s20, 0
    s_add_u32 s16, s16, 135168
    buffer_load_dwordx4 v8, s[44:47], s17 offen offset:0 lds
    buffer_load_dwordx4 v9, s[44:47], s17 offen offset:1024 lds
    s_add_u32 s17, s17, 110592
    ds_read_b64_tr_b16 v[24:25], v22 offset:32768
    ds_read_b64_tr_b16 v[26:27], v22 offset:33280
    ds_read_b64_tr_b16 v[28:29], v22 offset:36864
    ds_read_b64_tr_b16 v[30:31], v22 offset:37376
    ds_read_b64_tr_b16 v[32:33], v20 offset:32768
    ds_read_b64_tr_b16 v[34:35], v20 offset:33280
    ds_read_b64_tr_b16 v[36:37], v21 offset:32768
    ds_read_b64_tr_b16 v[38:39], v21 offset:33280
    s_waitcnt lgkmcnt(8)
    v_mfma_f32_32x32x16_bf16 v[56:71], v[40:43], v[48:51], v[56:71]
    v_mfma_f32_32x32x16_bf16 v[72:87], v[40:43], v[52:55], v[72:87]
    v_mfma_f32_32x32x16_bf16 v[88:103], v[44:47], v[48:51], v[88:103]
    v_mfma_f32_32x32x16_bf16 v[104:119], v[44:47], v[52:55], v[104:119]
    ds_read_b64_tr_b16 v[40:41], v22 offset:34816
    ds_read_b64_tr_b16 v[42:43], v22 offset:35328
    ds_read_b64_tr_b16 v[44:45], v22 offset:38912
    ds_read_b64_tr_b16 v[46:47], v22 offset:39424
    ds_read_b64_tr_b16 v[48:49], v20 offset:34816
    ds_read_b64_tr_b16 v[50:51], v20 offset:35328
    ds_read_b64_tr_b16 v[52:53], v21 offset:34816
    ds_read_b64_tr_b16 v[54:55], v21 offset:35328
    s_waitcnt lgkmcnt(8)
    v_mfma_f32_32x32x16_bf16 v[56:71], v[24:27], v[32:35], v[56:71]
    v_mfma_f32_32x32x16_bf16 v[72:87], v[24:27], v[36:39], v[72:87]
    v_mfma_f32_32x32x16_bf16 v[88:103], v[28:31], v[32:35], v[88:103]
    v_mfma_f32_32x32x16_bf16 v[104:119], v[28:31], v[36:39], v[104:119]
    s_waitcnt vmcnt(4)
    s_barrier
    s_add_u32 m0, s19, 16384
    s_nop 0
    buffer_load_dwordx4 v6, s[4:7], s16 offen offset:0 lds
    buffer_load_dwordx4 v7, s[4:7], s16 offen offset:1024 lds
    s_add_u32 m0, s20, 16384
    s_add_u32 s16, s16, 135168
    buffer_load_dwordx4 v8, s[44:47], s17 offen offset:0 lds
    buffer_load_dwordx4 v9, s[44:47], s17 offen offset:1024 lds
    s_add_u32 s17, s17, 110592
    ds_read_b64_tr_b16 v[24:25], v22 offset:49152
    ds_read_b64_tr_b16 v[26:27], v22 offset:49664
    ds_read_b64_tr_b16 v[28:29], v22 offset:53248
    ds_read_b64_tr_b16 v[30:31], v22 offset:53760
    ds_read_b64_tr_b16 v[32:33], v20 offset:49152
    ds_read_b64_tr_b16 v[34:35], v20 offset:49664
    ds_read_b64_tr_b16 v[36:37], v21 offset:49152
    ds_read_b64_tr_b16 v[38:39], v21 offset:49664
    s_waitcnt lgkmcnt(8)
    v_mfma_f32_32x32x16_bf16 v[56:71], v[40:43], v[48:51], v[56:71]
    v_mfma_f32_32x32x16_bf16 v[72:87], v[40:43], v[52:55], v[72:87]
    v_mfma_f32_32x32x16_bf16 v[88:103], v[44:47], v[48:51], v[88:103]
    v_mfma_f32_32x32x16_bf16 v[104:119], v[44:47], v[52:55], v[104:119]
    s_mov_b32 s39, 4
gemm1_kernel_loop:
    ds_read_b64_tr_b16 v[40:41], v22 offset:51200
    ds_read_b64_tr_b16 v[42:43], v22 offset:51712
    ds_read_b64_tr_b16 v[44:45], v22 offset:55296
    ds_read_b64_tr_b16 v[46:47], v22 offset:55808
    ds_read_b64_tr_b16 v[48:49], v20 offset:51200
    ds_read_b64_tr_b16 v[50:51], v20 offset:51712
    ds_read_b64_tr_b16 v[52:53], v21 offset:51200
    ds_read_b64_tr_b16 v[54:55], v21 offset:51712
    s_waitcnt lgkmcnt(8)
    v_mfma_f32_32x32x16_bf16 v[56:71], v[24:27], v[32:35], v[56:71]
    v_mfma_f32_32x32x16_bf16 v[72:87], v[24:27], v[36:39], v[72:87]
    v_mfma_f32_32x32x16_bf16 v[88:103], v[28:31], v[32:35], v[88:103]
    v_mfma_f32_32x32x16_bf16 v[104:119], v[28:31], v[36:39], v[104:119]
    s_waitcnt vmcnt(4)
    s_barrier
    s_add_u32 m0, s19, 32768
    s_nop 0
    buffer_load_dwordx4 v6, s[4:7], s16 offen offset:0 lds
    buffer_load_dwordx4 v7, s[4:7], s16 offen offset:1024 lds
    s_add_u32 m0, s20, 32768
    s_add_u32 s16, s16, 135168
    buffer_load_dwordx4 v8, s[44:47], s17 offen offset:0 lds
    buffer_load_dwordx4 v9, s[44:47], s17 offen offset:1024 lds
    s_add_u32 s17, s17, 110592
    ds_read_b64_tr_b16 v[24:25], v22 offset:0
    ds_read_b64_tr_b16 v[26:27], v22 offset:512
    ds_read_b64_tr_b16 v[28:29], v22 offset:4096
    ds_read_b64_tr_b16 v[30:31], v22 offset:4608
    ds_read_b64_tr_b16 v[32:33], v20 offset:0
    ds_read_b64_tr_b16 v[34:35], v20 offset:512
    ds_read_b64_tr_b16 v[36:37], v21 offset:0
    ds_read_b64_tr_b16 v[38:39], v21 offset:512
    s_waitcnt lgkmcnt(8)
    v_mfma_f32_32x32x16_bf16 v[56:71], v[40:43], v[48:51], v[56:71]
    v_mfma_f32_32x32x16_bf16 v[72:87], v[40:43], v[52:55], v[72:87]
    v_mfma_f32_32x32x16_bf16 v[88:103], v[44:47], v[48:51], v[88:103]
    v_mfma_f32_32x32x16_bf16 v[104:119], v[44:47], v[52:55], v[104:119]
    ds_read_b64_tr_b16 v[40:41], v22 offset:2048
    ds_read_b64_tr_b16 v[42:43], v22 offset:2560
    ds_read_b64_tr_b16 v[44:45], v22 offset:6144
    ds_read_b64_tr_b16 v[46:47], v22 offset:6656
    ds_read_b64_tr_b16 v[48:49], v20 offset:2048
    ds_read_b64_tr_b16 v[50:51], v20 offset:2560
    ds_read_b64_tr_b16 v[52:53], v21 offset:2048
    ds_read_b64_tr_b16 v[54:55], v21 offset:2560
    s_waitcnt lgkmcnt(8)
    v_mfma_f32_32x32x16_bf16 v[56:71], v[24:27], v[32:35], v[56:71]
    v_mfma_f32_32x32x16_bf16 v[72:87], v[24:27], v[36:39], v[72:87]
    v_mfma_f32_32x32x16_bf16 v[88:103], v[28:31], v[32:35], v[88:103]
    v_mfma_f32_32x32x16_bf16 v[104:119], v[28:31], v[36:39], v[104:119]
    s_waitcnt vmcnt(4)
    s_barrier
    s_add_u32 m0, s19, 49152
    s_nop 0
    buffer_load_dwordx4 v6, s[4:7], s16 offen offset:0 lds
    buffer_load_dwordx4 v7, s[4:7], s16 offen offset:1024 lds
    s_add_u32 m0, s20, 49152
    s_add_u32 s16, s16, 135168
    buffer_load_dwordx4 v8, s[44:47], s17 offen offset:0 lds
    buffer_load_dwordx4 v9, s[44:47], s17 offen offset:1024 lds
    s_add_u32 s17, s17, 110592
    ds_read_b64_tr_b16 v[24:25], v22 offset:16384
    ds_read_b64_tr_b16 v[26:27], v22 offset:16896
    ds_read_b64_tr_b16 v[28:29], v22 offset:20480
    ds_read_b64_tr_b16 v[30:31], v22 offset:20992
    ds_read_b64_tr_b16 v[32:33], v20 offset:16384
    ds_read_b64_tr_b16 v[34:35], v20 offset:16896
    ds_read_b64_tr_b16 v[36:37], v21 offset:16384
    ds_read_b64_tr_b16 v[38:39], v21 offset:16896
    s_waitcnt lgkmcnt(8)
    v_mfma_f32_32x32x16_bf16 v[56:71], v[40:43], v[48:51], v[56:71]
    v_mfma_f32_32x32x16_bf16 v[72:87], v[40:43], v[52:55], v[72:87]
    v_mfma_f32_32x32x16_bf16 v[88:103], v[44:47], v[48:51], v[88:103]
    v_mfma_f32_32x32x16_bf16 v[104:119], v[44:47], v[52:55], v[104:119]
    ds_read_b64_tr_b16 v[40:41], v22 offset:18432
    ds_read_b64_tr_b16 v[42:43], v22 offset:18944
    ds_read_b64_tr_b16 v[44:45], v22 offset:22528
    ds_read_b64_tr_b16 v[46:47], v22 offset:23040
    ds_read_b64_tr_b16 v[48:49], v20 offset:18432
    ds_read_b64_tr_b16 v[50:51], v20 offset:18944
    ds_read_b64_tr_b16 v[52:53], v21 offset:18432
    ds_read_b64_tr_b16 v[54:55], v21 offset:18944
    s_waitcnt lgkmcnt(8)
    v_mfma_f32_32x32x16_bf16 v[56:71], v[24:27], v[32:35], v[56:71]
    v_mfma_f32_32x32x16_bf16 v[72:87], v[24:27], v[36:39], v[72:87]
    v_mfma_f32_32x32x16_bf16 v[88:103], v[28:31], v[32:35], v[88:103]
    v_mfma_f32_32x32x16_bf16 v[104:119], v[28:31], v[36:39], v[104:119]
    s_waitcnt vmcnt(4)
    s_barrier
    s_add_u32 m0, s19, 0
    s_nop 0
    buffer_load_dwordx4 v6, s[4:7], s16 offen offset:0 lds
    buffer_load_dwordx4 v7, s[4:7], s16 offen offset:1024 lds
    s_add_u32 m0, s20, 0
    s_add_u32 s16, s16, 135168
    buffer_load_dwordx4 v8, s[44:47], s17 offen offset:0 lds
    buffer_load_dwordx4 v9, s[44:47], s17 offen offset:1024 lds
    s_add_u32 s17, s17, 110592
    ds_read_b64_tr_b16 v[24:25], v22 offset:32768
    ds_read_b64_tr_b16 v[26:27], v22 offset:33280
    ds_read_b64_tr_b16 v[28:29], v22 offset:36864
    ds_read_b64_tr_b16 v[30:31], v22 offset:37376
    ds_read_b64_tr_b16 v[32:33], v20 offset:32768
    ds_read_b64_tr_b16 v[34:35], v20 offset:33280
    ds_read_b64_tr_b16 v[36:37], v21 offset:32768
    ds_read_b64_tr_b16 v[38:39], v21 offset:33280
    s_waitcnt lgkmcnt(8)
    v_mfma_f32_32x32x16_bf16 v[56:71], v[40:43], v[48:51], v[56:71]
    v_mfma_f32_32x32x16_bf16 v[72:87], v[40:43], v[52:55], v[72:87]
    v_mfma_f32_32x32x16_bf16 v[88:103], v[44:47], v[48:51], v[88:103]
    v_mfma_f32_32x32x16_bf16 v[104:119], v[44:47], v[52:55], v[104:119]
    ds_read_b64_tr_b16 v[40:41], v22 offset:34816
    ds_read_b64_tr_b16 v[42:43], v22 offset:35328
    ds_read_b64_tr_b16 v[44:45], v22 offset:38912
    ds_read_b64_tr_b16 v[46:47], v22 offset:39424
    ds_read_b64_tr_b16 v[48:49], v20 offset:34816
    ds_read_b64_tr_b16 v[50:51], v20 offset:35328
    ds_read_b64_tr_b16 v[52:53], v21 offset:34816
    ds_read_b64_tr_b16 v[54:55], v21 offset:35328
    s_waitcnt lgkmcnt(8)
    v_mfma_f32_32x32x16_bf16 v[56:71], v[24:27], v[32:35], v[56:71]
    v_mfma_f32_32x32x16_bf16 v[72:87], v[24:27], v[36:39], v[72:87]
    v_mfma_f32_32x32x16_bf16 v[88:103], v[28:31], v[32:35], v[88:103]
    v_mfma_f32_32x32x16_bf16 v[104:119], v[28:31], v[36:39], v[104:119]
    s_waitcnt vmcnt(4)
    s_barrier
    s_add_u32 m0, s19, 16384
    s_nop 0
    buffer_load_dwordx4 v6, s[4:7], s16 offen offset:0 lds
    buffer_load_dwordx4 v7, s[4:7], s16 offen offset:1024 lds
    s_add_u32 m0, s20, 16384
    s_add_u32 s16, s16, 135168
    buffer_load_dwordx4 v8, s[44:47], s17 offen offset:0 lds
    buffer_load_dwordx4 v9, s[44:47], s17 offen offset:1024 lds
    s_add_u32 s17, s17, 110592
    ds_read_b64_tr_b16 v[24:25], v22 offset:49152
    ds_read_b64_tr_b16 v[26:27], v22 offset:49664
    ds_read_b64_tr_b16 v[28:29], v22 offset:53248
    ds_read_b64_tr_b16 v[30:31], v22 offset:53760
    ds_read_b64_tr_b16 v[32:33], v20 offset:49152
    ds_read_b64_tr_b16 v[34:35], v20 offset:49664
    ds_read_b64_tr_b16 v[36:37], v21 offset:49152
    ds_read_b64_tr_b16 v[38:39], v21 offset:49664
    s_waitcnt lgkmcnt(8)
    v_mfma_f32_32x32x16_bf16 v[56:71], v[40:43], v[48:51], v[56:71]
    v_mfma_f32_32x32x16_bf16 v[72:87], v[40:43], v[52:55], v[72:87]
    v_mfma_f32_32x32x16_bf16 v[88:103], v[44:47], v[48:51], v[88:103]
    v_mfma_f32_32x32x16_bf16 v[104:119], v[44:47], v[52:55], v[104:119]
    s_sub_u32 s39, s39, 1
    s_cmp_lg_u32 s39, 0
    s_cbranch_scc1 gemm1_kernel_loop
    ds_read_b64_tr_b16 v[40:41], v22 offset:51200
    ds_read_b64_tr_b16 v[42:43], v22 offset:51712
    ds_read_b64_tr_b16 v[44:45], v22 offset:55296
    ds_read_b64_tr_b16 v[46:47], v22 offset:55808
    ds_read_b64_tr_b16 v[48:49], v20 offset:51200
    ds_read_b64_tr_b16 v[50:51], v20 offset:51712
    ds_read_b64_tr_b16 v[52:53], v21 offset:51200
    ds_read_b64_tr_b16 v[54:55], v21 offset:51712
    s_waitcnt lgkmcnt(8)
    v_mfma_f32_32x32x16_bf16 v[56:71], v[24:27], v[32:35], v[56:71]
    v_mfma_f32_32x32x16_bf16 v[72:87], v[24:27], v[36:39], v[72:87]
    v_mfma_f32_32x32x16_bf16 v[88:103], v[28:31], v[32:35], v[88:103]
    v_mfma_f32_32x32x16_bf16 v[104:119], v[28:31], v[36:39], v[104:119]
    s_waitcnt lgkmcnt(0)
    v_mfma_f32_32x32x16_bf16 v[56:71], v[40:43], v[48:51], v[56:71]
    v_mfma_f32_32x32x16_bf16 v[72:87], v[40:43], v[52:55], v[72:87]
    v_mfma_f32_32x32x16_bf16 v[88:103], v[44:47], v[48:51], v[88:103]
    v_mfma_f32_32x32x16_bf16 v[104:119], v[44:47], v[52:55], v[104:119]
    s_mov_b32 s25, 0xffff0000
    s_lshl_b32 s32, s12, 3
    v_mov_b32 v3, s32
gemm1_kernel_poll:
    buffer_load_dwordx2 v[24:25], v3, s[52:55], 0 offen sc1
    s_waitcnt vmcnt(0)
    v_and_b32 v24, v24, v25
    s_nop 0
    v_readfirstlane_b32 s33, v24
    s_nop 3
    s_cmp_eq_u32 s33, 1
    s_cbranch_scc1 gemm1_kernel_pollok
    s_sleep 2
    s_branch gemm1_kernel_poll
gemm1_kernel_pollok:
    s_lshl_b32 s32, s12, 7
    v_lshl_add_u32 v3, v12, 6, v10
    v_add_u32 v3, s32, v3
    v_lshlrev_b32 v3, 3, v3
    s_mov_b32 s32, 44040192
    buffer_load_dwordx2 v[24:25], v3, s[4:7], s32 offen sc1
    buffer_load_dwordx2 v[26:27], v3, s[4:7], s32 offen offset:256 sc1
    s_waitcnt vmcnt(0)
    s_mov_b32 s40, 0x3acccccd
    s_waitcnt lgkmcnt(0)
    v_mul_f32 v5, s40, v24
    v_mul_f32 v6, s40, v25
    v_fma_f32 v6, -v5, v5, v6
    v_max_f32 v6, 0, v6
    v_cvt_pk_bf16_f32 v6, v6, v5
    v_and_b32 v120, s25, v6
    v_lshlrev_b32 v6, 16, v6
    v_add_f32 v6, 0x3727c5ac, v6
    v_cvt_pk_bf16_f32 v6, v6, v6
    v_lshlrev_b32 v6, 16, v6
    v_sqrt_f32 v6, v6
    s_nop 0
    v_cvt_pk_bf16_f32 v6, v6, v6
    v_lshlrev_b32 v6, 16, v6
    v_rcp_f32 v122, v6
    v_mul_f32 v5, s40, v26
    v_mul_f32 v6, s40, v27
    v_fma_f32 v6, -v5, v5, v6
    v_max_f32 v6, 0, v6
    v_cvt_pk_bf16_f32 v6, v6, v5
    v_and_b32 v121, s25, v6
    v_lshlrev_b32 v6, 16, v6
    v_add_f32 v6, 0x3727c5ac, v6
    v_cvt_pk_bf16_f32 v6, v6, v6
    v_lshlrev_b32 v6, 16, v6
    v_sqrt_f32 v6, v6
    s_nop 0
    v_cvt_pk_bf16_f32 v6, v6, v6
    v_lshlrev_b32 v6, 16, v6
    v_rcp_f32 v123, v6
    s_mov_b32 s27, 28311552
    s_add_u32 s28, s27, 110592
    v_mov_b32 v19, 0x3d372713
    v_mov_b32 v20, 0x40135761
    v_sub_f32 v216, 0, v120
    v_sub_f32 v217, 0, v120
    v_mov_b32 v220, v122
    v_mov_b32 v221, v122
    v_sub_f32 v218, 0, v121
    v_sub_f32 v219, 0, v121
    v_mov_b32 v222, v123
    v_mov_b32 v223, v123
    v_mov_b32 v224, 0x3d372713
    v_mov_b32 v225, 0x3d372713
    v_mov_b32 v226, 0x40135761
    v_mov_b32 v227, 0x40135761
    v_pk_fma_f32 v[56:57], v[216:217], v[160:161], v[56:57]
    v_pk_fma_f32 v[88:89], v[216:217], v[176:177], v[88:89]
    v_pk_mul_f32 v[56:57], v[56:57], v[220:221]
    v_pk_mul_f32 v[88:89], v[88:89], v[220:221]
    v_cvt_pk_bf16_f32 v200, v56, v57
    v_cvt_pk_bf16_f32 v201, v88, v89
    v_lshlrev_b32 v192, 16, v200
    v_and_b32 v193, s25, v200
    v_lshlrev_b32 v196, 16, v201
    v_and_b32 v197, s25, v201
    v_pk_mul_f32 v[200:201], v[192:193], v[192:193]
    v_pk_mul_f32 v[200:201], v[200:201], v[224:225]
    v_pk_fma_f32 v[200:201], v[200:201], v[192:193], v[192:193]
    v_pk_mul_f32 v[200:201], v[200:201], v[226:227]
    v_pk_fma_f32 v[58:59], v[216:217], v[162:163], v[58:59]
    v_pk_fma_f32 v[90:91], v[216:217], v[178:179], v[90:91]
    v_pk_mul_f32 v[58:59], v[58:59], v[220:221]
    v_pk_mul_f32 v[90:91], v[90:91], v[220:221]
    v_cvt_pk_bf16_f32 v202, v58, v59
    v_cvt_pk_bf16_f32 v203, v90, v91
    v_lshlrev_b32 v194, 16, v202
    v_and_b32 v195, s25, v202
    v_lshlrev_b32 v198, 16, v203
    v_and_b32 v199, s25, v203
    v_pk_mul_f32 v[202:203], v[194:195], v[194:195]
    v_pk_mul_f32 v[202:203], v[202:203], v[224:225]
    v_pk_fma_f32 v[202:203], v[202:203], v[194:195], v[194:195]
    v_pk_mul_f32 v[202:203], v[202:203], v[226:227]
    v_exp_f32 v200, v200
    v_exp_f32 v201, v201
    v_exp_f32 v202, v202
    v_exp_f32 v203, v203
    s_nop 0
    v_add_f32 v200, 1.0, v200
    v_add_f32 v201, 1.0, v201
    v_add_f32 v202, 1.0, v202
    v_add_f32 v203, 1.0, v203
    v_rcp_f32 v200, v200
    v_rcp_f32 v201, v201
    v_rcp_f32 v202, v202
    v_rcp_f32 v203, v203
    s_nop 0
    v_pk_fma_f32 v[200:201], v[192:193], v[200:201], v[192:193] neg_lo:[1,0,0] neg_hi:[1,0,0]
    v_cvt_pk_bf16_f32 v200, v200, v201
    v_and_b32 v201, s25, v200
    v_lshlrev_b32 v200, 16, v200
    v_pk_mul_f32 v[200:201], v[200:201], v[196:197]
    v_cvt_pk_bf16_f32 v208, v200, v201
    v_pk_fma_f32 v[202:203], v[194:195], v[202:203], v[194:195] neg_lo:[1,0,0] neg_hi:[1,0,0]
    v_cvt_pk_bf16_f32 v202, v202, v203
    v_and_b32 v203, s25, v202
    v_lshlrev_b32 v202, 16, v202
    v_pk_mul_f32 v[202:203], v[202:203], v[198:199]
    v_cvt_pk_bf16_f32 v209, v202, v203
    buffer_store_dwordx2 v[208:209], v17, s[4:7], s27 offen offset:0
    v_pk_fma_f32 v[60:61], v[216:217], v[164:165], v[60:61]
    v_pk_fma_f32 v[92:93], v[216:217], v[180:181], v[92:93]
    v_pk_mul_f32 v[60:61], v[60:61], v[220:221]
    v_pk_mul_f32 v[92:93], v[92:93], v[220:221]
    v_cvt_pk_bf16_f32 v200, v60, v61
    v_cvt_pk_bf16_f32 v201, v92, v93
    v_lshlrev_b32 v192, 16, v200
    v_and_b32 v193, s25, v200
    v_lshlrev_b32 v196, 16, v201
    v_and_b32 v197, s25, v201
    v_pk_mul_f32 v[200:201], v[192:193], v[192:193]
    v_pk_mul_f32 v[200:201], v[200:201], v[224:225]
    v_pk_fma_f32 v[200:201], v[200:201], v[192:193], v[192:193]
    v_pk_mul_f32 v[200:201], v[200:201], v[226:227]
    v_pk_fma_f32 v[62:63], v[216:217], v[166:167], v[62:63]
    v_pk_fma_f32 v[94:95], v[216:217], v[182:183], v[94:95]
    v_pk_mul_f32 v[62:63], v[62:63], v[220:221]
    v_pk_mul_f32 v[94:95], v[94:95], v[220:221]
    v_cvt_pk_bf16_f32 v202, v62, v63
    v_cvt_pk_bf16_f32 v203, v94, v95
    v_lshlrev_b32 v194, 16, v202
    v_and_b32 v195, s25, v202
    v_lshlrev_b32 v198, 16, v203
    v_and_b32 v199, s25, v203
    v_pk_mul_f32 v[202:203], v[194:195], v[194:195]
    v_pk_mul_f32 v[202:203], v[202:203], v[224:225]
    v_pk_fma_f32 v[202:203], v[202:203], v[194:195], v[194:195]
    v_pk_mul_f32 v[202:203], v[202:203], v[226:227]
    v_exp_f32 v200, v200
    v_exp_f32 v201, v201
    v_exp_f32 v202, v202
    v_exp_f32 v203, v203
    s_nop 0
    v_add_f32 v200, 1.0, v200
    v_add_f32 v201, 1.0, v201
    v_add_f32 v202, 1.0, v202
    v_add_f32 v203, 1.0, v203
    v_rcp_f32 v200, v200
    v_rcp_f32 v201, v201
    v_rcp_f32 v202, v202
    v_rcp_f32 v203, v203
    s_nop 0
    v_pk_fma_f32 v[200:201], v[192:193], v[200:201], v[192:193] neg_lo:[1,0,0] neg_hi:[1,0,0]
    v_cvt_pk_bf16_f32 v200, v200, v201
    v_and_b32 v201, s25, v200
    v_lshlrev_b32 v200, 16, v200
    v_pk_mul_f32 v[200:201], v[200:201], v[196:197]
    v_cvt_pk_bf16_f32 v210, v200, v201
    v_pk_fma_f32 v[202:203], v[194:195], v[202:203], v[194:195] neg_lo:[1,0,0] neg_hi:[1,0,0]
    v_cvt_pk_bf16_f32 v202, v202, v203
    v_and_b32 v203, s25, v202
    v_lshlrev_b32 v202, 16, v202
    v_pk_mul_f32 v[202:203], v[202:203], v[198:199]
    v_cvt_pk_bf16_f32 v211, v202, v203
    buffer_store_dwordx2 v[210:211], v17, s[4:7], s27 offen offset:16
    v_pk_fma_f32 v[64:65], v[216:217], v[168:169], v[64:65]
    v_pk_fma_f32 v[96:97], v[216:217], v[184:185], v[96:97]
    v_pk_mul_f32 v[64:65], v[64:65], v[220:221]
    v_pk_mul_f32 v[96:97], v[96:97], v[220:221]
    v_cvt_pk_bf16_f32 v200, v64, v65
    v_cvt_pk_bf16_f32 v201, v96, v97
    v_lshlrev_b32 v192, 16, v200
    v_and_b32 v193, s25, v200
    v_lshlrev_b32 v196, 16, v201
    v_and_b32 v197, s25, v201
    v_pk_mul_f32 v[200:201], v[192:193], v[192:193]
    v_pk_mul_f32 v[200:201], v[200:201], v[224:225]
    v_pk_fma_f32 v[200:201], v[200:201], v[192:193], v[192:193]
    v_pk_mul_f32 v[200:201], v[200:201], v[226:227]
    v_pk_fma_f32 v[66:67], v[216:217], v[170:171], v[66:67]
    v_pk_fma_f32 v[98:99], v[216:217], v[186:187], v[98:99]
    v_pk_mul_f32 v[66:67], v[66:67], v[220:221]
    v_pk_mul_f32 v[98:99], v[98:99], v[220:221]
    v_cvt_pk_bf16_f32 v202, v66, v67
    v_cvt_pk_bf16_f32 v203, v98, v99
    v_lshlrev_b32 v194, 16, v202
    v_and_b32 v195, s25, v202
    v_lshlrev_b32 v198, 16, v203
    v_and_b32 v199, s25, v203
    v_pk_mul_f32 v[202:203], v[194:195], v[194:195]
    v_pk_mul_f32 v[202:203], v[202:203], v[224:225]
    v_pk_fma_f32 v[202:203], v[202:203], v[194:195], v[194:195]
    v_pk_mul_f32 v[202:203], v[202:203], v[226:227]
    v_exp_f32 v200, v200
    v_exp_f32 v201, v201
    v_exp_f32 v202, v202
    v_exp_f32 v203, v203
    s_nop 0
    v_add_f32 v200, 1.0, v200
    v_add_f32 v201, 1.0, v201
    v_add_f32 v202, 1.0, v202
    v_add_f32 v203, 1.0, v203
    v_rcp_f32 v200, v200
    v_rcp_f32 v201, v201
    v_rcp_f32 v202, v202
    v_rcp_f32 v203, v203
    s_nop 0
    v_pk_fma_f32 v[200:201], v[192:193], v[200:201], v[192:193] neg_lo:[1,0,0] neg_hi:[1,0,0]
    v_cvt_pk_bf16_f32 v200, v200, v201
    v_and_b32 v201, s25, v200
    v_lshlrev_b32 v200, 16, v200
    v_pk_mul_f32 v[200:201], v[200:201], v[196:197]
    v_cvt_pk_bf16_f32 v212, v200, v201
    v_pk_fma_f32 v[202:203], v[194:195], v[202:203], v[194:195] neg_lo:[1,0,0] neg_hi:[1,0,0]
    v_cvt_pk_bf16_f32 v202, v202, v203
    v_and_b32 v203, s25, v202
    v_lshlrev_b32 v202, 16, v202
    v_pk_mul_f32 v[202:203], v[202:203], v[198:199]
    v_cvt_pk_bf16_f32 v213, v202, v203
    buffer_store_dwordx2 v[212:213], v17, s[4:7], s27 offen offset:32
    v_pk_fma_f32 v[68:69], v[216:217], v[172:173], v[68:69]
    v_pk_fma_f32 v[100:101], v[216:217], v[188:189], v[100:101]
    v_pk_mul_f32 v[68:69], v[68:69], v[220:221]
    v_pk_mul_f32 v[100:101], v[100:101], v[220:221]
    v_cvt_pk_bf16_f32 v200, v68, v69
    v_cvt_pk_bf16_f32 v201, v100, v101
    v_lshlrev_b32 v192, 16, v200
    v_and_b32 v193, s25, v200
    v_lshlrev_b32 v196, 16, v201
    v_and_b32 v197, s25, v201
    v_pk_mul_f32 v[200:201], v[192:193], v[192:193]
    v_pk_mul_f32 v[200:201], v[200:201], v[224:225]
    v_pk_fma_f32 v[200:201], v[200:201], v[192:193], v[192:193]
    v_pk_mul_f32 v[200:201], v[200:201], v[226:227]
    v_pk_fma_f32 v[70:71], v[216:217], v[174:175], v[70:71]
    v_pk_fma_f32 v[102:103], v[216:217], v[190:191], v[102:103]
    v_pk_mul_f32 v[70:71], v[70:71], v[220:221]
    v_pk_mul_f32 v[102:103], v[102:103], v[220:221]
    v_cvt_pk_bf16_f32 v202, v70, v71
    v_cvt_pk_bf16_f32 v203, v102, v103
    v_lshlrev_b32 v194, 16, v202
    v_and_b32 v195, s25, v202
    v_lshlrev_b32 v198, 16, v203
    v_and_b32 v199, s25, v203
    v_pk_mul_f32 v[202:203], v[194:195], v[194:195]
    v_pk_mul_f32 v[202:203], v[202:203], v[224:225]
    v_pk_fma_f32 v[202:203], v[202:203], v[194:195], v[194:195]
    v_pk_mul_f32 v[202:203], v[202:203], v[226:227]
    v_exp_f32 v200, v200
    v_exp_f32 v201, v201
    v_exp_f32 v202, v202
    v_exp_f32 v203, v203
    s_nop 0
    v_add_f32 v200, 1.0, v200
    v_add_f32 v201, 1.0, v201
    v_add_f32 v202, 1.0, v202
    v_add_f32 v203, 1.0, v203
    v_rcp_f32 v200, v200
    v_rcp_f32 v201, v201
    v_rcp_f32 v202, v202
    v_rcp_f32 v203, v203
    s_nop 0
    v_pk_fma_f32 v[200:201], v[192:193], v[200:201], v[192:193] neg_lo:[1,0,0] neg_hi:[1,0,0]
    v_cvt_pk_bf16_f32 v200, v200, v201
    v_and_b32 v201, s25, v200
    v_lshlrev_b32 v200, 16, v200
    v_pk_mul_f32 v[200:201], v[200:201], v[196:197]
    v_cvt_pk_bf16_f32 v214, v200, v201
    v_pk_fma_f32 v[202:203], v[194:195], v[202:203], v[194:195] neg_lo:[1,0,0] neg_hi:[1,0,0]
    v_cvt_pk_bf16_f32 v202, v202, v203
    v_and_b32 v203, s25, v202
    v_lshlrev_b32 v202, 16, v202
    v_pk_mul_f32 v[202:203], v[202:203], v[198:199]
    v_cvt_pk_bf16_f32 v215, v202, v203
    buffer_store_dwordx2 v[214:215], v17, s[4:7], s27 offen offset:48
    v_pk_fma_f32 v[72:73], v[218:219], v[160:161], v[72:73]
    v_pk_fma_f32 v[104:105], v[218:219], v[176:177], v[104:105]
    v_pk_mul_f32 v[72:73], v[72:73], v[222:223]
    v_pk_mul_f32 v[104:105], v[104:105], v[222:223]
    v_cvt_pk_bf16_f32 v200, v72, v73
    v_cvt_pk_bf16_f32 v201, v104, v105
    v_lshlrev_b32 v192, 16, v200
    v_and_b32 v193, s25, v200
    v_lshlrev_b32 v196, 16, v201
    v_and_b32 v197, s25, v201
    v_pk_mul_f32 v[200:201], v[192:193], v[192:193]
    v_pk_mul_f32 v[200:201], v[200:201], v[224:225]
    v_pk_fma_f32 v[200:201], v[200:201], v[192:193], v[192:193]
    v_pk_mul_f32 v[200:201], v[200:201], v[226:227]
    v_pk_fma_f32 v[74:75], v[218:219], v[162:163], v[74:75]
    v_pk_fma_f32 v[106:107], v[218:219], v[178:179], v[106:107]
    v_pk_mul_f32 v[74:75], v[74:75], v[222:223]
    v_pk_mul_f32 v[106:107], v[106:107], v[222:223]
    v_cvt_pk_bf16_f32 v202, v74, v75
    v_cvt_pk_bf16_f32 v203, v106, v107
    v_lshlrev_b32 v194, 16, v202
    v_and_b32 v195, s25, v202
    v_lshlrev_b32 v198, 16, v203
    v_and_b32 v199, s25, v203
    v_pk_mul_f32 v[202:203], v[194:195], v[194:195]
    v_pk_mul_f32 v[202:203], v[202:203], v[224:225]
    v_pk_fma_f32 v[202:203], v[202:203], v[194:195], v[194:195]
    v_pk_mul_f32 v[202:203], v[202:203], v[226:227]
    v_exp_f32 v200, v200
    v_exp_f32 v201, v201
    v_exp_f32 v202, v202
    v_exp_f32 v203, v203
    s_nop 0
    v_add_f32 v200, 1.0, v200
    v_add_f32 v201, 1.0, v201
    v_add_f32 v202, 1.0, v202
    v_add_f32 v203, 1.0, v203
    v_rcp_f32 v200, v200
    v_rcp_f32 v201, v201
    v_rcp_f32 v202, v202
    v_rcp_f32 v203, v203
    s_nop 0
    v_pk_fma_f32 v[200:201], v[192:193], v[200:201], v[192:193] neg_lo:[1,0,0] neg_hi:[1,0,0]
    v_cvt_pk_bf16_f32 v200, v200, v201
    v_and_b32 v201, s25, v200
    v_lshlrev_b32 v200, 16, v200
    v_pk_mul_f32 v[200:201], v[200:201], v[196:197]
    v_cvt_pk_bf16_f32 v208, v200, v201
    v_pk_fma_f32 v[202:203], v[194:195], v[202:203], v[194:195] neg_lo:[1,0,0] neg_hi:[1,0,0]
    v_cvt_pk_bf16_f32 v202, v202, v203
    v_and_b32 v203, s25, v202
    v_lshlrev_b32 v202, 16, v202
    v_pk_mul_f32 v[202:203], v[202:203], v[198:199]
    v_cvt_pk_bf16_f32 v209, v202, v203
    buffer_store_dwordx2 v[208:209], v17, s[4:7], s28 offen offset:0
    v_pk_fma_f32 v[76:77], v[218:219], v[164:165], v[76:77]
    v_pk_fma_f32 v[108:109], v[218:219], v[180:181], v[108:109]
    v_pk_mul_f32 v[76:77], v[76:77], v[222:223]
    v_pk_mul_f32 v[108:109], v[108:109], v[222:223]
    v_cvt_pk_bf16_f32 v200, v76, v77
    v_cvt_pk_bf16_f32 v201, v108, v109
    v_lshlrev_b32 v192, 16, v200
    v_and_b32 v193, s25, v200
    v_lshlrev_b32 v196, 16, v201
    v_and_b32 v197, s25, v201
    v_pk_mul_f32 v[200:201], v[192:193], v[192:193]
    v_pk_mul_f32 v[200:201], v[200:201], v[224:225]
    v_pk_fma_f32 v[200:201], v[200:201], v[192:193], v[192:193]
    v_pk_mul_f32 v[200:201], v[200:201], v[226:227]
    v_pk_fma_f32 v[78:79], v[218:219], v[166:167], v[78:79]
    v_pk_fma_f32 v[110:111], v[218:219], v[182:183], v[110:111]
    v_pk_mul_f32 v[78:79], v[78:79], v[222:223]
    v_pk_mul_f32 v[110:111], v[110:111], v[222:223]
    v_cvt_pk_bf16_f32 v202, v78, v79
    v_cvt_pk_bf16_f32 v203, v110, v111
    v_lshlrev_b32 v194, 16, v202
    v_and_b32 v195, s25, v202
    v_lshlrev_b32 v198, 16, v203
    v_and_b32 v199, s25, v203
    v_pk_mul_f32 v[202:203], v[194:195], v[194:195]
    v_pk_mul_f32 v[202:203], v[202:203], v[224:225]
    v_pk_fma_f32 v[202:203], v[202:203], v[194:195], v[194:195]
    v_pk_mul_f32 v[202:203], v[202:203], v[226:227]
    v_exp_f32 v200, v200
    v_exp_f32 v201, v201
    v_exp_f32 v202, v202
    v_exp_f32 v203, v203
    s_nop 0
    v_add_f32 v200, 1.0, v200
    v_add_f32 v201, 1.0, v201
    v_add_f32 v202, 1.0, v202
    v_add_f32 v203, 1.0, v203
    v_rcp_f32 v200, v200
    v_rcp_f32 v201, v201
    v_rcp_f32 v202, v202
    v_rcp_f32 v203, v203
    s_nop 0
    v_pk_fma_f32 v[200:201], v[192:193], v[200:201], v[192:193] neg_lo:[1,0,0] neg_hi:[1,0,0]
    v_cvt_pk_bf16_f32 v200, v200, v201
    v_and_b32 v201, s25, v200
    v_lshlrev_b32 v200, 16, v200
    v_pk_mul_f32 v[200:201], v[200:201], v[196:197]
    v_cvt_pk_bf16_f32 v210, v200, v201
    v_pk_fma_f32 v[202:203], v[194:195], v[202:203], v[194:195] neg_lo:[1,0,0] neg_hi:[1,0,0]
    v_cvt_pk_bf16_f32 v202, v202, v203
    v_and_b32 v203, s25, v202
    v_lshlrev_b32 v202, 16, v202
    v_pk_mul_f32 v[202:203], v[202:203], v[198:199]
    v_cvt_pk_bf16_f32 v211, v202, v203
    buffer_store_dwordx2 v[210:211], v17, s[4:7], s28 offen offset:16
    v_pk_fma_f32 v[80:81], v[218:219], v[168:169], v[80:81]
    v_pk_fma_f32 v[112:113], v[218:219], v[184:185], v[112:113]
    v_pk_mul_f32 v[80:81], v[80:81], v[222:223]
    v_pk_mul_f32 v[112:113], v[112:113], v[222:223]
    v_cvt_pk_bf16_f32 v200, v80, v81
    v_cvt_pk_bf16_f32 v201, v112, v113
    v_lshlrev_b32 v192, 16, v200
    v_and_b32 v193, s25, v200
    v_lshlrev_b32 v196, 16, v201
    v_and_b32 v197, s25, v201
    v_pk_mul_f32 v[200:201], v[192:193], v[192:193]
    v_pk_mul_f32 v[200:201], v[200:201], v[224:225]
    v_pk_fma_f32 v[200:201], v[200:201], v[192:193], v[192:193]
    v_pk_mul_f32 v[200:201], v[200:201], v[226:227]
    v_pk_fma_f32 v[82:83], v[218:219], v[170:171], v[82:83]
    v_pk_fma_f32 v[114:115], v[218:219], v[186:187], v[114:115]
    v_pk_mul_f32 v[82:83], v[82:83], v[222:223]
    v_pk_mul_f32 v[114:115], v[114:115], v[222:223]
    v_cvt_pk_bf16_f32 v202, v82, v83
    v_cvt_pk_bf16_f32 v203, v114, v115
    v_lshlrev_b32 v194, 16, v202
    v_and_b32 v195, s25, v202
    v_lshlrev_b32 v198, 16, v203
    v_and_b32 v199, s25, v203
    v_pk_mul_f32 v[202:203], v[194:195], v[194:195]
    v_pk_mul_f32 v[202:203], v[202:203], v[224:225]
    v_pk_fma_f32 v[202:203], v[202:203], v[194:195], v[194:195]
    v_pk_mul_f32 v[202:203], v[202:203], v[226:227]
    v_exp_f32 v200, v200
    v_exp_f32 v201, v201
    v_exp_f32 v202, v202
    v_exp_f32 v203, v203
    s_nop 0
    v_add_f32 v200, 1.0, v200
    v_add_f32 v201, 1.0, v201
    v_add_f32 v202, 1.0, v202
    v_add_f32 v203, 1.0, v203
    v_rcp_f32 v200, v200
    v_rcp_f32 v201, v201
    v_rcp_f32 v202, v202
    v_rcp_f32 v203, v203
    s_nop 0
    v_pk_fma_f32 v[200:201], v[192:193], v[200:201], v[192:193] neg_lo:[1,0,0] neg_hi:[1,0,0]
    v_cvt_pk_bf16_f32 v200, v200, v201
    v_and_b32 v201, s25, v200
    v_lshlrev_b32 v200, 16, v200
    v_pk_mul_f32 v[200:201], v[200:201], v[196:197]
    v_cvt_pk_bf16_f32 v212, v200, v201
    v_pk_fma_f32 v[202:203], v[194:195], v[202:203], v[194:195] neg_lo:[1,0,0] neg_hi:[1,0,0]
    v_cvt_pk_bf16_f32 v202, v202, v203
    v_and_b32 v203, s25, v202
    v_lshlrev_b32 v202, 16, v202
    v_pk_mul_f32 v[202:203], v[202:203], v[198:199]
    v_cvt_pk_bf16_f32 v213, v202, v203
    buffer_store_dwordx2 v[212:213], v17, s[4:7], s28 offen offset:32
    v_pk_fma_f32 v[84:85], v[218:219], v[172:173], v[84:85]
    v_pk_fma_f32 v[116:117], v[218:219], v[188:189], v[116:117]
    v_pk_mul_f32 v[84:85], v[84:85], v[222:223]
    v_pk_mul_f32 v[116:117], v[116:117], v[222:223]
    v_cvt_pk_bf16_f32 v200, v84, v85
    v_cvt_pk_bf16_f32 v201, v116, v117
    v_lshlrev_b32 v192, 16, v200
    v_and_b32 v193, s25, v200
    v_lshlrev_b32 v196, 16, v201
    v_and_b32 v197, s25, v201
    v_pk_mul_f32 v[200:201], v[192:193], v[192:193]
    v_pk_mul_f32 v[200:201], v[200:201], v[224:225]
    v_pk_fma_f32 v[200:201], v[200:201], v[192:193], v[192:193]
    v_pk_mul_f32 v[200:201], v[200:201], v[226:227]
    v_pk_fma_f32 v[86:87], v[218:219], v[174:175], v[86:87]
    v_pk_fma_f32 v[118:119], v[218:219], v[190:191], v[118:119]
    v_pk_mul_f32 v[86:87], v[86:87], v[222:223]
    v_pk_mul_f32 v[118:119], v[118:119], v[222:223]
    v_cvt_pk_bf16_f32 v202, v86, v87
    v_cvt_pk_bf16_f32 v203, v118, v119
    v_lshlrev_b32 v194, 16, v202
    v_and_b32 v195, s25, v202
    v_lshlrev_b32 v198, 16, v203
    v_and_b32 v199, s25, v203
    v_pk_mul_f32 v[202:203], v[194:195], v[194:195]
    v_pk_mul_f32 v[202:203], v[202:203], v[224:225]
    v_pk_fma_f32 v[202:203], v[202:203], v[194:195], v[194:195]
    v_pk_mul_f32 v[202:203], v[202:203], v[226:227]
    v_exp_f32 v200, v200
    v_exp_f32 v201, v201
    v_exp_f32 v202, v202
    v_exp_f32 v203, v203
    s_nop 0
    v_add_f32 v200, 1.0, v200
    v_add_f32 v201, 1.0, v201
    v_add_f32 v202, 1.0, v202
    v_add_f32 v203, 1.0, v203
    v_rcp_f32 v200, v200
    v_rcp_f32 v201, v201
    v_rcp_f32 v202, v202
    v_rcp_f32 v203, v203
    s_nop 0
    v_pk_fma_f32 v[200:201], v[192:193], v[200:201], v[192:193] neg_lo:[1,0,0] neg_hi:[1,0,0]
    v_cvt_pk_bf16_f32 v200, v200, v201
    v_and_b32 v201, s25, v200
    v_lshlrev_b32 v200, 16, v200
    v_pk_mul_f32 v[200:201], v[200:201], v[196:197]
    v_cvt_pk_bf16_f32 v214, v200, v201
    v_pk_fma_f32 v[202:203], v[194:195], v[202:203], v[194:195] neg_lo:[1,0,0] neg_hi:[1,0,0]
    v_cvt_pk_bf16_f32 v202, v202, v203
    v_and_b32 v203, s25, v202
    v_lshlrev_b32 v202, 16, v202
    v_pk_mul_f32 v[202:203], v[202:203], v[198:199]
    v_cvt_pk_bf16_f32 v215, v202, v203
    buffer_store_dwordx2 v[214:215], v17, s[4:7], s28 offen offset:48
    s_endpgm
gemm1_kernel_stats:
    s_waitcnt lgkmcnt(0)
    s_and_b32 s5, s5, 0xffff
    s_mov_b32 s6, 268435456
    s_mov_b32 s7, 0x00020000
    s_and_b32 s45, s45, 0xffff
    s_mov_b32 s46, 2211840
    s_mov_b32 s47, 0x00020000
    s_and_b32 s49, s49, 0xffff
    s_mov_b32 s50, 2211840
    s_mov_b32 s51, 0x00020000
    s_and_b32 s53, s53, 0xffff
    s_mov_b32 s54, 256
    s_mov_b32 s55, 0x00020000
    v_and_b32 v1, 31, v0
    v_lshrrev_b32 v2, 5, v0
    v_mul_u32_u24 v3, 337920, v2
    v_lshl_add_u32 v3, v1, 2, v3
    s_lshl_b32 s14, s2, 7
    s_add_u32 s14, s14, 39845888
    v_mov_b32 v4, 0
    v_mov_b32 v5, 0
    v_mov_b32 v6, 0
    v_mov_b32 v7, 0
    s_mov_b32 s41, 0xffff0000
    s_mov_b32 s15, 0
gemm1_kernel_stl:
    s_add_u32 s16, s14, 0
    buffer_load_dword v16, v3, s[4:7], s16 offen
    s_add_u32 s16, s14, 4224
    buffer_load_dword v17, v3, s[4:7], s16 offen
    s_add_u32 s16, s14, 8448
    buffer_load_dword v18, v3, s[4:7], s16 offen
    s_add_u32 s16, s14, 12672
    buffer_load_dword v19, v3, s[4:7], s16 offen
    s_add_u32 s16, s14, 16896
    buffer_load_dword v20, v3, s[4:7], s16 offen
    s_add_u32 s16, s14, 21120
    buffer_load_dword v21, v3, s[4:7], s16 offen
    s_add_u32 s16, s14, 25344
    buffer_load_dword v22, v3, s[4:7], s16 offen
    s_add_u32 s16, s14, 29568
    buffer_load_dword v23, v3, s[4:7], s16 offen
    s_add_u32 s16, s14, 33792
    buffer_load_dword v24, v3, s[4:7], s16 offen
    s_add_u32 s16, s14, 38016
    buffer_load_dword v25, v3, s[4:7], s16 offen
    s_add_u32 s16, s14, 42240
    buffer_load_dword v26, v3, s[4:7], s16 offen
    s_add_u32 s16, s14, 46464
    buffer_load_dword v27, v3, s[4:7], s16 offen
    s_add_u32 s16, s14, 50688
    buffer_load_dword v28, v3, s[4:7], s16 offen
    s_add_u32 s16, s14, 54912
    buffer_load_dword v29, v3, s[4:7], s16 offen
    s_add_u32 s16, s14, 59136
    buffer_load_dword v30, v3, s[4:7], s16 offen
    s_add_u32 s16, s14, 63360
    buffer_load_dword v31, v3, s[4:7], s16 offen
    s_add_u32 s14, s14, 67584
    s_waitcnt vmcnt(15)
    v_lshlrev_b32 v8, 16, v16
    v_and_b32 v9, s41, v16
    v_add_f32 v4, v4, v8
    v_fmac_f32 v5, v8, v8
    v_add_f32 v6, v6, v9
    v_fmac_f32 v7, v9, v9
    s_waitcnt vmcnt(14)
    v_lshlrev_b32 v8, 16, v17
    v_and_b32 v9, s41, v17
    v_add_f32 v4, v4, v8
    v_fmac_f32 v5, v8, v8
    v_add_f32 v6, v6, v9
    v_fmac_f32 v7, v9, v9
    s_waitcnt vmcnt(13)
    v_lshlrev_b32 v8, 16, v18
    v_and_b32 v9, s41, v18
    v_add_f32 v4, v4, v8
    v_fmac_f32 v5, v8, v8
    v_add_f32 v6, v6, v9
    v_fmac_f32 v7, v9, v9
    s_waitcnt vmcnt(12)
    v_lshlrev_b32 v8, 16, v19
    v_and_b32 v9, s41, v19
    v_add_f32 v4, v4, v8
    v_fmac_f32 v5, v8, v8
    v_add_f32 v6, v6, v9
    v_fmac_f32 v7, v9, v9
    s_waitcnt vmcnt(11)
    v_lshlrev_b32 v8, 16, v20
    v_and_b32 v9, s41, v20
    v_add_f32 v4, v4, v8
    v_fmac_f32 v5, v8, v8
    v_add_f32 v6, v6, v9
    v_fmac_f32 v7, v9, v9
    s_waitcnt vmcnt(10)
    v_lshlrev_b32 v8, 16, v21
    v_and_b32 v9, s41, v21
    v_add_f32 v4, v4, v8
    v_fmac_f32 v5, v8, v8
    v_add_f32 v6, v6, v9
    v_fmac_f32 v7, v9, v9
    s_waitcnt vmcnt(9)
    v_lshlrev_b32 v8, 16, v22
    v_and_b32 v9, s41, v22
    v_add_f32 v4, v4, v8
    v_fmac_f32 v5, v8, v8
    v_add_f32 v6, v6, v9
    v_fmac_f32 v7, v9, v9
    s_waitcnt vmcnt(8)
    v_lshlrev_b32 v8, 16, v23
    v_and_b32 v9, s41, v23
    v_add_f32 v4, v4, v8
    v_fmac_f32 v5, v8, v8
    v_add_f32 v6, v6, v9
    v_fmac_f32 v7, v9, v9
    s_waitcnt vmcnt(7)
    v_lshlrev_b32 v8, 16, v24
    v_and_b32 v9, s41, v24
    v_add_f32 v4, v4, v8
    v_fmac_f32 v5, v8, v8
    v_add_f32 v6, v6, v9
    v_fmac_f32 v7, v9, v9
    s_waitcnt vmcnt(6)
    v_lshlrev_b32 v8, 16, v25
    v_and_b32 v9, s41, v25
    v_add_f32 v4, v4, v8
    v_fmac_f32 v5, v8, v8
    v_add_f32 v6, v6, v9
    v_fmac_f32 v7, v9, v9
    s_waitcnt vmcnt(5)
    v_lshlrev_b32 v8, 16, v26
    v_and_b32 v9, s41, v26
    v_add_f32 v4, v4, v8
    v_fmac_f32 v5, v8, v8
    v_add_f32 v6, v6, v9
    v_fmac_f32 v7, v9, v9
    s_waitcnt vmcnt(4)
    v_lshlrev_b32 v8, 16, v27
    v_and_b32 v9, s41, v27
    v_add_f32 v4, v4, v8
    v_fmac_f32 v5, v8, v8
    v_add_f32 v6, v6, v9
    v_fmac_f32 v7, v9, v9
    s_waitcnt vmcnt(3)
    v_lshlrev_b32 v8, 16, v28
    v_and_b32 v9, s41, v28
    v_add_f32 v4, v4, v8
    v_fmac_f32 v5, v8, v8
    v_add_f32 v6, v6, v9
    v_fmac_f32 v7, v9, v9
    s_waitcnt vmcnt(2)
    v_lshlrev_b32 v8, 16, v29
    v_and_b32 v9, s41, v29
    v_add_f32 v4, v4, v8
    v_fmac_f32 v5, v8, v8
    v_add_f32 v6, v6, v9
    v_fmac_f32 v7, v9, v9
    s_waitcnt vmcnt(1)
    v_lshlrev_b32 v8, 16, v30
    v_and_b32 v9, s41, v30
    v_add_f32 v4, v4, v8
    v_fmac_f32 v5, v8, v8
    v_add_f32 v6, v6, v9
    v_fmac_f32 v7, v9, v9
    s_waitcnt vmcnt(0)
    v_lshlrev_b32 v8, 16, v31
    v_and_b32 v9, s41, v31
    v_add_f32 v4, v4, v8
    v_fmac_f32 v5, v8, v8
    v_add_f32 v6, v6, v9
    v_fmac_f32 v7, v9, v9
    s_add_u32 s15, s15, 1
    s_cmp_lt_u32 s15, 5
    s_cbranch_scc1 gemm1_kernel_stl
    v_lshlrev_b32 v8, 4, v0
    ds_write_b128 v8, v[4:7]
    s_waitcnt lgkmcnt(0)
    s_barrier
    v_lshlrev_b32 v8, 4, v1
    ds_read_b128 v[16:19], v8 offset:0
    ds_read_b128 v[20:23], v8 offset:512
    ds_read_b128 v[24:27], v8 offset:1024
    ds_read_b128 v[28:31], v8 offset:1536
    ds_read_b128 v[32:35], v8 offset:2048
    ds_read_b128 v[36:39], v8 offset:2560
    ds_read_b128 v[40:43], v8 offset:3072
    ds_read_b128 v[44:47], v8 offset:3584
    s_waitcnt lgkmcnt(0)
    v_add_f32 v16, v16, v20
    v_add_f32 v17, v17, v21
    v_add_f32 v18, v18, v22
    v_add_f32 v19, v19, v23
    v_add_f32 v16, v16, v24
    v_add_f32 v17, v17, v25
    v_add_f32 v18, v18, v26
    v_add_f32 v19, v19, v27
    v_add_f32 v16, v16, v28
    v_add_f32 v17, v17, v29
    v_add_f32 v18, v18, v30
    v_add_f32 v19, v19, v31
    v_add_f32 v16, v16, v32
    v_add_f32 v17, v17, v33
    v_add_f32 v18, v18, v34
    v_add_f32 v19, v19, v35
    v_add_f32 v16, v16, v36
    v_add_f32 v17, v17, v37
    v_add_f32 v18, v18, v38
    v_add_f32 v19, v19, v39
    v_add_f32 v16, v16, v40
    v_add_f32 v17, v17, v41
    v_add_f32 v18, v18, v42
    v_add_f32 v19, v19, v43
    v_add_f32 v16, v16, v44
    v_add_f32 v17, v17, v45
    v_add_f32 v18, v18, v46
    v_add_f32 v19, v19, v47
    s_lshl_b32 s14, s2, 9
    s_add_u32 s14, s14, 44040192
    v_cmp_gt_u32 vcc, 32, v0
    s_and_saveexec_b64 s[16:17], vcc
    s_cbranch_execz gemm1_kernel_stskip
    buffer_store_dwordx4 v[16:19], v8, s[4:7], s14 offen sc1
    s_waitcnt vmcnt(0)
gemm1_kernel_stskip:
    s_mov_b64 exec, s[16:17]
    s_barrier
    v_cmp_eq_u32 vcc, 0, v0
    s_and_saveexec_b64 s[16:17], vcc
    s_cbranch_execz gemm1_kernel_end
    s_lshl_b32 s14, s2, 2
    v_mov_b32 v4, s14
    v_mov_b32 v5, 1
    buffer_store_dword v5, v4, s[52:55], 0 offen sc1
gemm1_kernel_end:
    s_endpgm
.globl gemm2_kernel
.p2align 8
.type gemm2_kernel,@function
gemm2_kernel:
    s_cmp_ge_u32 s2, 160
    s_cbranch_scc1 gemm2_kernel_end
    s_load_dwordx2 s[4:5], s[0:1], 104
    s_load_dwordx2 s[8:9], s[0:1], 88
    s_load_dwordx2 s[44:45], s[0:1], 80
    v_lshrrev_b32 v1, 6, v0
    v_and_b32 v2, 63, v0
    s_mov_b32 s3, s2
    s_and_b32 s12, s3, 15
    v_readfirstlane_b32 s14, v1
    s_lshr_b32 s13, s3, 4
    v_lshrrev_b32 v4, 4, v2
    v_and_b32 v4, 1, v4
    v_lshlrev_b32 v4, 2, v4
    v_and_b32 v5, 7, v2
    v_xor_b32 v19, v4, v5
    v_lshrrev_b32 v3, 3, v2
    v_mul_u32_u24 v4, 1280, v3
    v_lshl_add_u32 v52, v19, 4, v4
    v_add_u32 v53, 9216, v52
    s_movk_i32 s15, 3456
    v_mul_lo_u32 v3, v3, s15
    v_and_b32 v4, 7, v2
    v_lshrrev_b32 v5, 4, v2
    v_xor_b32 v4, v4, v5
    v_xor_b32 v5, 4, v4
    v_lshl_add_u32 v4, v4, 4, v3
    v_lshl_add_u32 v5, v5, 4, v3
    v_add_u32 v6, 0, v4
    v_add_u32 v7, 26624, v5
    v_add_u32 v8, 53248, v4
    v_add_u32 v9, 79872, v5
    s_waitcnt lgkmcnt(0)
    s_and_b32 s5, s5, 0xffff
    s_mov_b32 s6, 268435456
    s_mov_b32 s7, 0x00020000
    s_and_b32 s9, s9, 0xffff
    s_mov_b32 s10, 2621440
    s_mov_b32 s11, 0x00020000
    s_and_b32 s45, s45, 0xffff
    s_mov_b32 s46, 2211840
    s_mov_b32 s47, 0x00020000
    s_mul_i32 s16, s12, 128
    s_lshl_b32 s17, s14, 5
    s_add_u32 s16, s16, s17
    s_mul_i32 s16, s16, s15
    s_add_u32 s16, s16, 28311552
    s_mul_i32 s17, s14, 20480
    s_lshl_b32 s18, s13, 7
    s_add_u32 s17, s17, s18
    s_lshl_b32 s19, s14, 12
    s_lshl_b32 s20, s14, 11
    s_add_u32 s20, s20, 16384
    s_add_u32 m0, s19, 0
    s_nop 0
    buffer_load_dwordx4 v6, s[4:7], s16 offen offset:0 lds
    buffer_load_dwordx4 v7, s[4:7], s16 offen offset:1024 lds
    buffer_load_dwordx4 v8, s[4:7], s16 offen offset:2048 lds
    buffer_load_dwordx4 v9, s[4:7], s16 offen offset:3072 lds
    s_add_u32 m0, s20, 0
    s_add_u32 s16, s16, 128
    buffer_load_dwordx4 v52, s[44:47], s17 offen offset:0 lds
    buffer_load_dwordx4 v53, s[44:47], s17 offen offset:1024 lds
    s_add_u32 s17, s17, 81920
    s_add_u32 m0, s19, 24576
    s_nop 0
    buffer_load_dwordx4 v6, s[4:7], s16 offen offset:0 lds
    buffer_load_dwordx4 v7, s[4:7], s16 offen offset:1024 lds
    buffer_load_dwordx4 v8, s[4:7], s16 offen offset:2048 lds
    buffer_load_dwordx4 v9, s[4:7], s16 offen offset:3072 lds
    s_add_u32 m0, s20, 24576
    s_add_u32 s16, s16, 128
    buffer_load_dwordx4 v52, s[44:47], s17 offen offset:0 lds
    buffer_load_dwordx4 v53, s[44:47], s17 offen offset:1024 lds
    s_add_u32 s17, s17, 81920
    s_add_u32 m0, s19, 49152
    s_nop 0
    buffer_load_dwordx4 v6, s[4:7], s16 offen offset:0 lds
    buffer_load_dwordx4 v7, s[4:7], s16 offen offset:1024 lds
    buffer_load_dwordx4 v8, s[4:7], s16 offen offset:2048 lds
    buffer_load_dwordx4 v9, s[4:7], s16 offen offset:3072 lds
    s_add_u32 m0, s20, 49152
    s_add_u32 s16, s16, 128
    buffer_load_dwordx4 v52, s[44:47], s17 offen offset:0 lds
    buffer_load_dwordx4 v53, s[44:47], s17 offen offset:1024 lds
    s_add_u32 s17, s17, 81920
    s_add_u32 m0, s19, 73728
    s_nop 0
    buffer_load_dwordx4 v6, s[4:7], s16 offen offset:0 lds
    buffer_load_dwordx4 v7, s[4:7], s16 offen offset:1024 lds
    buffer_load_dwordx4 v8, s[4:7], s16 offen offset:2048 lds
    buffer_load_dwordx4 v9, s[4:7], s16 offen offset:3072 lds
    s_add_u32 m0, s20, 73728
    s_add_u32 s16, s16, 128
    buffer_load_dwordx4 v52, s[44:47], s17 offen offset:0 lds
    buffer_load_dwordx4 v53, s[44:47], s17 offen offset:1024 lds
    s_add_u32 s17, s17, 81920
    s_add_u32 m0, s19, 98304
    s_nop 0
    buffer_load_dwordx4 v6, s[4:7], s16 offen offset:0 lds
    buffer_load_dwordx4 v7, s[4:7], s16 offen offset:1024 lds
    buffer_load_dwordx4 v8, s[4:7], s16 offen offset:2048 lds
    buffer_load_dwordx4 v9, s[4:7], s16 offen offset:3072 lds
    s_add_u32 m0, s20, 98304
    s_add_u32 s16, s16, 128
    buffer_load_dwordx4 v52, s[44:47], s17 offen offset:0 lds
    buffer_load_dwordx4 v53, s[44:47], s17 offen offset:1024 lds
    s_add_u32 s17, s17, 81920
    v_and_b32 v10, 31, v2
    v_lshrrev_b32 v11, 5, v2
    v_and_b32 v12, 1, v1
    v_lshrrev_b32 v13, 1, v1
    v_and_b32 v14, 15, v2
    v_lshrrev_b32 v14, 2, v14
    v_lshl_add_u32 v14, v11, 3, v14
    v_lshlrev_b32 v14, 7, v14
    v_lshrrev_b32 v3, 4, v2
    v_and_b32 v3, 1, v3
    v_lshlrev_b32 v3, 1, v3
    v_and_b32 v4, 3, v2
    v_lshrrev_b32 v4, 1, v4
    v_add_u32 v3, v3, v4
    v_lshrrev_b32 v4, 3, v2
    v_and_b32 v4, 1, v4
    v_lshlrev_b32 v4, 2, v4
    v_xor_b32 v3, v3, v4
    v_lshl_add_u32 v14, v3, 4, v14
    v_and_b32 v4, 1, v2
    v_lshl_add_u32 v14, v4, 3, v14
    v_lshlrev_b32 v3, 6, v13
    v_xor_b32 v16, v3, v14
    v_add_u32 v16, 16384, v16
    v_lshrrev_b32 v3, 1, v10
    v_and_b32 v3, 7, v3
    v_xor_b32 v3, v3, v11
    v_lshlrev_b32 v3, 4, v3
    v_lshl_add_u32 v15, v12, 6, v10
    v_lshl_add_u32 v15, v15, 7, v3
    v_xor_b32 v20, 0, v15
    v_xor_b32 v21, 32, v15
    v_xor_b32 v22, 64, v15
    v_xor_b32 v23, 96, v15
    v_add_u32 v24, 0, v16
    v_xor_b32 v25, 0, v15
    v_add_u32 v25, 24576, v25
    v_xor_b32 v26, 32, v15
    v_add_u32 v26, 24576, v26
    v_xor_b32 v27, 64, v15
    v_add_u32 v27, 24576, v27
    v_xor_b32 v28, 96, v15
    v_add_u32 v28, 24576, v28
    v_add_u32 v29, 24576, v16
    v_xor_b32 v30, 0, v15
    v_add_u32 v30, 49152, v30
    v_xor_b32 v31, 32, v15
    v_add_u32 v31, 49152, v31
    v_xor_b32 v32, 64, v15
    v_add_u32 v32, 49152, v32
    v_xor_b32 v33, 96, v15
    v_add_u32 v33, 49152, v33
    v_add_u32 v34, 49152, v16
    v_xor_b32 v35, 0, v15
    v_add_u32 v35, 73728, v35
    v_xor_b32 v36, 32, v15
    v_add_u32 v36, 73728, v36
    v_xor_b32 v37, 64, v15
    v_add_u32 v37, 73728, v37
    v_xor_b32 v38, 96, v15
    v_add_u32 v38, 73728, v38
    v_add_u32 v39, 73728, v16
    v_xor_b32 v40, 0, v15
    v_add_u32 v40, 98304, v40
    v_xor_b32 v41, 32, v15
    v_add_u32 v41, 98304, v41
    v_xor_b32 v42, 64, v15
    v_add_u32 v42, 98304, v42
    v_xor_b32 v43, 96, v15
    v_add_u32 v43, 98304, v43
    v_add_u32 v44, 98304, v16
    v_xor_b32 v45, 0, v15
    v_add_u32 v45, 122880, v45
    v_xor_b32 v46, 32, v15
    v_add_u32 v46, 122880, v46
    v_xor_b32 v47, 64, v15
    v_add_u32 v47, 122880, v47
    v_xor_b32 v48, 96, v15
    v_add_u32 v48, 122880, v48
    v_add_u32 v49, 122880, v16
    v_mov_b32 v120, 0
    v_mov_b32 v121, 0
    v_mov_b32 v122, 0
    v_mov_b32 v123, 0
    v_mov_b32 v124, 0
    v_mov_b32 v125, 0
    v_mov_b32 v126, 0
    v_mov_b32 v127, 0
    v_mov_b32 v128, 0
    v_mov_b32 v129, 0
    v_mov_b32 v130, 0
    v_mov_b32 v131, 0
    v_mov_b32 v132, 0
    v_mov_b32 v133, 0
    v_mov_b32 v134, 0
    v_mov_b32 v135, 0
    v_mov_b32 v136, 0
    v_mov_b32 v137, 0
    v_mov_b32 v138, 0
    v_mov_b32 v139, 0
    v_mov_b32 v140, 0
    v_mov_b32 v141, 0
    v_mov_b32 v142, 0
    v_mov_b32 v143, 0
    v_mov_b32 v144, 0
    v_mov_b32 v145, 0
    v_mov_b32 v146, 0
    v_mov_b32 v147, 0
    v_mov_b32 v148, 0
    v_mov_b32 v149, 0
    v_mov_b32 v150, 0
    v_mov_b32 v151, 0
    s_mul_i32 s22, s12, 128
    v_lshl_add_u32 v17, v12, 6, v10
    v_add_u32 v17, s22, v17
    s_lshl_b32 s22, s13, 6
    v_lshlrev_b32 v18, 5, v13
    v_lshl_add_u32 v18, v11, 2, v18
    v_add_u32 v18, s22, v18
    v_mul_u32_u24 v3, 4224, v18
    v_lshl_add_u32 v3, v17, 1, v3
    s_mov_b32 s27, 39845888
    buffer_load_ushort v184, v3, s[4:7], s27 offen offset:0
    buffer_load_ushort v200, v3, s[4:7], s27 offen offset:64
    s_mov_b32 s27, 39850112
    buffer_load_ushort v185, v3, s[4:7], s27 offen offset:0
    buffer_load_ushort v201, v3, s[4:7], s27 offen offset:64
    s_mov_b32 s27, 39854336
    buffer_load_ushort v186, v3, s[4:7], s27 offen offset:0
    buffer_load_ushort v202, v3, s[4:7], s27 offen offset:64
    s_mov_b32 s27, 39858560
    buffer_load_ushort v187, v3, s[4:7], s27 offen offset:0
    buffer_load_ushort v203, v3, s[4:7], s27 offen offset:64
    s_mov_b32 s27, 39879680
    buffer_load_ushort v188, v3, s[4:7], s27 offen offset:0
    buffer_load_ushort v204, v3, s[4:7], s27 offen offset:64
    s_mov_b32 s27, 39883904
    buffer_load_ushort v189, v3, s[4:7], s27 offen offset:0
    buffer_load_ushort v205, v3, s[4:7], s27 offen offset:64
    s_mov_b32 s27, 39888128
    buffer_load_ushort v190, v3, s[4:7], s27 offen offset:0
    buffer_load_ushort v206, v3, s[4:7], s27 offen offset:64
    s_mov_b32 s27, 39892352
    buffer_load_ushort v191, v3, s[4:7], s27 offen offset:0
    buffer_load_ushort v207, v3, s[4:7], s27 offen offset:64
    s_mov_b32 s27, 39913472
    buffer_load_ushort v192, v3, s[4:7], s27 offen offset:0
    buffer_load_ushort v208, v3, s[4:7], s27 offen offset:64
    s_mov_b32 s27, 39917696
    buffer_load_ushort v193, v3, s[4:7], s27 offen offset:0
    buffer_load_ushort v209, v3, s[4:7], s27 offen offset:64
    s_mov_b32 s27, 39921920
    buffer_load_ushort v194, v3, s[4:7], s27 offen offset:0
    buffer_load_ushort v210, v3, s[4:7], s27 offen offset:64
    s_mov_b32 s27, 39926144
    buffer_load_ushort v195, v3, s[4:7], s27 offen offset:0
    buffer_load_ushort v211, v3, s[4:7], s27 offen offset:64
    s_mov_b32 s27, 39947264
    buffer_load_ushort v196, v3, s[4:7], s27 offen offset:0
    buffer_load_ushort v212, v3, s[4:7], s27 offen offset:64
    s_mov_b32 s27, 39951488
    buffer_load_ushort v197, v3, s[4:7], s27 offen offset:0
    buffer_load_ushort v213, v3, s[4:7], s27 offen offset:64
    s_mov_b32 s27, 39955712
    buffer_load_ushort v198, v3, s[4:7], s27 offen offset:0
    buffer_load_ushort v214, v3, s[4:7], s27 offen offset:64
    s_mov_b32 s27, 39959936
    buffer_load_ushort v199, v3, s[4:7], s27 offen offset:0
    buffer_load_ushort v215, v3, s[4:7], s27 offen offset:64
    s_movk_i32 s26, 1280
    v_mul_lo_u32 v17, v17, s26
    v_lshl_add_u32 v17, v18, 1, v17
    s_waitcnt vmcnt(56)
    s_barrier
    ds_read_b64_tr_b16 v[56:57], v24 offset:0
    ds_read_b64_tr_b16 v[58:59], v24 offset:512
    ds_read_b128 v[64:67], v20 offset:0
    ds_read_b128 v[68:71], v20 offset:4096
    ds_read_b64_tr_b16 v[72:73], v24 offset:2048
    ds_read_b64_tr_b16 v[74:75], v24 offset:2560
    ds_read_b128 v[80:83], v21 offset:0
    ds_read_b128 v[84:87], v21 offset:4096
    ds_read_b64_tr_b16 v[88:89], v24 offset:4096
    ds_read_b64_tr_b16 v[90:91], v24 offset:4608
    ds_read_b128 v[96:99], v22 offset:0
    ds_read_b128 v[100:103], v22 offset:4096
    ds_read_b64_tr_b16 v[104:105], v24 offset:6144
    ds_read_b64_tr_b16 v[106:107], v24 offset:6656
    ds_read_b128 v[112:115], v23 offset:0
    ds_read_b128 v[116:119], v23 offset:4096
    s_waitcnt lgkmcnt(12)
    v_mfma_f32_32x32x16_bf16 v[120:135], v[56:59], v[64:67], v[120:135]
    v_mfma_f32_32x32x16_bf16 v[136:151], v[56:59], v[68:71], v[136:151]
    s_waitcnt lgkmcnt(8)
    v_mfma_f32_32x32x16_bf16 v[120:135], v[72:75], v[80:83], v[120:135]
    v_mfma_f32_32x32x16_bf16 v[136:151], v[72:75], v[84:87], v[136:151]
    s_waitcnt vmcnt(18)
    s_barrier
    s_add_u32 m0, s19, 122880
    s_nop 0
    buffer_load_dwordx4 v6, s[4:7], s16 offen offset:0 lds
    buffer_load_dwordx4 v7, s[4:7], s16 offen offset:1024 lds
    buffer_load_dwordx4 v8, s[4:7], s16 offen offset:2048 lds
    buffer_load_dwordx4 v9, s[4:7], s16 offen offset:3072 lds
    s_add_u32 m0, s20, 122880
    s_add_u32 s16, s16, 128
    buffer_load_dwordx4 v52, s[44:47], s17 offen offset:0 lds
    buffer_load_dwordx4 v53, s[44:47], s17 offen offset:1024 lds
    s_add_u32 s17, s17, 81920
    ds_read_b64_tr_b16 v[56:57], v29 offset:0
    ds_read_b64_tr_b16 v[58:59], v29 offset:512
    ds_read_b128 v[64:67], v25 offset:0
    ds_read_b128 v[68:71], v25 offset:4096
    ds_read_b64_tr_b16 v[72:73], v29 offset:2048
    ds_read_b64_tr_b16 v[74:75], v29 offset:2560
    ds_read_b128 v[80:83], v26 offset:0
    ds_read_b128 v[84:87], v26 offset:4096
    s_waitcnt lgkmcnt(12)
    v_mfma_f32_32x32x16_bf16 v[120:135], v[88:91], v[96:99], v[120:135]
    v_mfma_f32_32x32x16_bf16 v[136:151], v[88:91], v[100:103], v[136:151]
    s_waitcnt lgkmcnt(8)
    v_mfma_f32_32x32x16_bf16 v[120:135], v[104:107], v[112:115], v[120:135]
    v_mfma_f32_32x32x16_bf16 v[136:151], v[104:107], v[116:119], v[136:151]
    ds_read_b64_tr_b16 v[88:89], v29 offset:4096
    ds_read_b64_tr_b16 v[90:91], v29 offset:4608
    ds_read_b128 v[96:99], v27 offset:0
    ds_read_b128 v[100:103], v27 offset:4096
    ds_read_b64_tr_b16 v[104:105], v29 offset:6144
    ds_read_b64_tr_b16 v[106:107], v29 offset:6656
    ds_read_b128 v[112:115], v28 offset:0
    ds_read_b128 v[116:119], v28 offset:4096
    s_waitcnt lgkmcnt(12)
    v_mfma_f32_32x32x16_bf16 v[120:135], v[56:59], v[64:67], v[120:135]
    v_mfma_f32_32x32x16_bf16 v[136:151], v[56:59], v[68:71], v[136:151]
    s_waitcnt lgkmcnt(8)
    v_mfma_f32_32x32x16_bf16 v[120:135], v[72:75], v[80:83], v[120:135]
    v_mfma_f32_32x32x16_bf16 v[136:151], v[72:75], v[84:87], v[136:151]
    s_waitcnt vmcnt(18)
    s_barrier
    s_add_u32 m0, s19, 0
    s_nop 0
    buffer_load_dwordx4 v6, s[4:7], s16 offen offset:0 lds
    buffer_load_dwordx4 v7, s[4:7], s16 offen offset:1024 lds
    buffer_load_dwordx4 v8, s[4:7], s16 offen offset:2048 lds
    buffer_load_dwordx4 v9, s[4:7], s16 offen offset:3072 lds
    s_add_u32 m0, s20, 0
    s_add_u32 s16, s16, 128
    buffer_load_dwordx4 v52, s[44:47], s17 offen offset:0 lds
    buffer_load_dwordx4 v53, s[44:47], s17 offen offset:1024 lds
    s_add_u32 s17, s17, 81920
    ds_read_b64_tr_b16 v[56:57], v34 offset:0
    ds_read_b64_tr_b16 v[58:59], v34 offset:512
    ds_read_b128 v[64:67], v30 offset:0
    ds_read_b128 v[68:71], v30 offset:4096
    ds_read_b64_tr_b16 v[72:73], v34 offset:2048
    ds_read_b64_tr_b16 v[74:75], v34 offset:2560
    ds_read_b128 v[80:83], v31 offset:0
    ds_read_b128 v[84:87], v31 offset:4096
    s_waitcnt lgkmcnt(12)
    v_mfma_f32_32x32x16_bf16 v[120:135], v[88:91], v[96:99], v[120:135]
    v_mfma_f32_32x32x16_bf16 v[136:151], v[88:91], v[100:103], v[136:151]
    s_waitcnt lgkmcnt(8)
    v_mfma_f32_32x32x16_bf16 v[120:135], v[104:107], v[112:115], v[120:135]
    v_mfma_f32_32x32x16_bf16 v[136:151], v[104:107], v[116:119], v[136:151]
    s_mov_b32 s39, 4
gemm2_kernel_loop:
    ds_read_b64_tr_b16 v[88:89], v34 offset:4096
    ds_read_b64_tr_b16 v[90:91], v34 offset:4608
    ds_read_b128 v[96:99], v32 offset:0
    ds_read_b128 v[100:103], v32 offset:4096
    ds_read_b64_tr_b16 v[104:105], v34 offset:6144
    ds_read_b64_tr_b16 v[106:107], v34 offset:6656
    ds_read_b128 v[112:115], v33 offset:0
    ds_read_b128 v[116:119], v33 offset:4096
    s_waitcnt lgkmcnt(12)
    v_mfma_f32_32x32x16_bf16 v[120:135], v[56:59], v[64:67], v[120:135]
    v_mfma_f32_32x32x16_bf16 v[136:151], v[56:59], v[68:71], v[136:151]
    s_waitcnt lgkmcnt(8)
    v_mfma_f32_32x32x16_bf16 v[120:135], v[72:75], v[80:83], v[120:135]
    v_mfma_f32_32x32x16_bf16 v[136:151], v[72:75], v[84:87], v[136:151]
    s_waitcnt vmcnt(18)
    s_barrier
    s_add_u32 m0, s19, 24576
    s_nop 0
    buffer_load_dwordx4 v6, s[4:7], s16 offen offset:0 lds
    buffer_load_dwordx4 v7, s[4:7], s16 offen offset:1024 lds
    buffer_load_dwordx4 v8, s[4:7], s16 offen offset:2048 lds
    buffer_load_dwordx4 v9, s[4:7], s16 offen offset:3072 lds
    s_add_u32 m0, s20, 24576
    s_add_u32 s16, s16, 128
    buffer_load_dwordx4 v52, s[44:47], s17 offen offset:0 lds
    buffer_load_dwordx4 v53, s[44:47], s17 offen offset:1024 lds
    s_add_u32 s17, s17, 81920
    ds_read_b64_tr_b16 v[56:57], v39 offset:0
    ds_read_b64_tr_b16 v[58:59], v39 offset:512
    ds_read_b128 v[64:67], v35 offset:0
    ds_read_b128 v[68:71], v35 offset:4096
    ds_read_b64_tr_b16 v[72:73], v39 offset:2048
    ds_read_b64_tr_b16 v[74:75], v39 offset:2560
    ds_read_b128 v[80:83], v36 offset:0
    ds_read_b128 v[84:87], v36 offset:4096
    s_waitcnt lgkmcnt(12)
    v_mfma_f32_32x32x16_bf16 v[120:135], v[88:91], v[96:99], v[120:135]
    v_mfma_f32_32x32x16_bf16 v[136:151], v[88:91], v[100:103], v[136:151]
    s_waitcnt lgkmcnt(8)
    v_mfma_f32_32x32x16_bf16 v[120:135], v[104:107], v[112:115], v[120:135]
    v_mfma_f32_32x32x16_bf16 v[136:151], v[104:107], v[116:119], v[136:151]
    ds_read_b64_tr_b16 v[88:89], v39 offset:4096
    ds_read_b64_tr_b16 v[90:91], v39 offset:4608
    ds_read_b128 v[96:99], v37 offset:0
    ds_read_b128 v[100:103], v37 offset:4096
    ds_read_b64_tr_b16 v[104:105], v39 offset:6144
    ds_read_b64_tr_b16 v[106:107], v39 offset:6656
    ds_read_b128 v[112:115], v38 offset:0
    ds_read_b128 v[116:119], v38 offset:4096
    s_waitcnt lgkmcnt(12)
    v_mfma_f32_32x32x16_bf16 v[120:135], v[56:59], v[64:67], v[120:135]
    v_mfma_f32_32x32x16_bf16 v[136:151], v[56:59], v[68:71], v[136:151]
    s_waitcnt lgkmcnt(8)
    v_mfma_f32_32x32x16_bf16 v[120:135], v[72:75], v[80:83], v[120:135]
    v_mfma_f32_32x32x16_bf16 v[136:151], v[72:75], v[84:87], v[136:151]
    s_waitcnt vmcnt(18)
    s_barrier
    s_add_u32 m0, s19, 49152
    s_nop 0
    buffer_load_dwordx4 v6, s[4:7], s16 offen offset:0 lds
    buffer_load_dwordx4 v7, s[4:7], s16 offen offset:1024 lds
    buffer_load_dwordx4 v8, s[4:7], s16 offen offset:2048 lds
    buffer_load_dwordx4 v9, s[4:7], s16 offen offset:3072 lds
    s_add_u32 m0, s20, 49152
    s_add_u32 s16, s16, 128
    buffer_load_dwordx4 v52, s[44:47], s17 offen offset:0 lds
    buffer_load_dwordx4 v53, s[44:47], s17 offen offset:1024 lds
    s_add_u32 s17, s17, 81920
    ds_read_b64_tr_b16 v[56:57], v44 offset:0
    ds_read_b64_tr_b16 v[58:59], v44 offset:512
    ds_read_b128 v[64:67], v40 offset:0
    ds_read_b128 v[68:71], v40 offset:4096
    ds_read_b64_tr_b16 v[72:73], v44 offset:2048
    ds_read_b64_tr_b16 v[74:75], v44 offset:2560
    ds_read_b128 v[80:83], v41 offset:0
    ds_read_b128 v[84:87], v41 offset:4096
    s_waitcnt lgkmcnt(12)
    v_mfma_f32_32x32x16_bf16 v[120:135], v[88:91], v[96:99], v[120:135]
    v_mfma_f32_32x32x16_bf16 v[136:151], v[88:91], v[100:103], v[136:151]
    s_waitcnt lgkmcnt(8)
    v_mfma_f32_32x32x16_bf16 v[120:135], v[104:107], v[112:115], v[120:135]
    v_mfma_f32_32x32x16_bf16 v[136:151], v[104:107], v[116:119], v[136:151]
    ds_read_b64_tr_b16 v[88:89], v44 offset:4096
    ds_read_b64_tr_b16 v[90:91], v44 offset:4608
    ds_read_b128 v[96:99], v42 offset:0
    ds_read_b128 v[100:103], v42 offset:4096
    ds_read_b64_tr_b16 v[104:105], v44 offset:6144
    ds_read_b64_tr_b16 v[106:107], v44 offset:6656
    ds_read_b128 v[112:115], v43 offset:0
    ds_read_b128 v[116:119], v43 offset:4096
    s_waitcnt lgkmcnt(12)
    v_mfma_f32_32x32x16_bf16 v[120:135], v[56:59], v[64:67], v[120:135]
    v_mfma_f32_32x32x16_bf16 v[136:151], v[56:59], v[68:71], v[136:151]
    s_waitcnt lgkmcnt(8)
    v_mfma_f32_32x32x16_bf16 v[120:135], v[72:75], v[80:83], v[120:135]
    v_mfma_f32_32x32x16_bf16 v[136:151], v[72:75], v[84:87], v[136:151]
    s_waitcnt vmcnt(18)
    s_barrier
    s_add_u32 m0, s19, 73728
    s_nop 0
    buffer_load_dwordx4 v6, s[4:7], s16 offen offset:0 lds
    buffer_load_dwordx4 v7, s[4:7], s16 offen offset:1024 lds
    buffer_load_dwordx4 v8, s[4:7], s16 offen offset:2048 lds
    buffer_load_dwordx4 v9, s[4:7], s16 offen offset:3072 lds
    s_add_u32 m0, s20, 73728
    s_add_u32 s16, s16, 128
    buffer_load_dwordx4 v52, s[44:47], s17 offen offset:0 lds
    buffer_load_dwordx4 v53, s[44:47], s17 offen offset:1024 lds
    s_add_u32 s17, s17, 81920
    ds_read_b64_tr_b16 v[56:57], v49 offset:0
    ds_read_b64_tr_b16 v[58:59], v49 offset:512
    ds_read_b128 v[64:67], v45 offset:0
    ds_read_b128 v[68:71], v45 offset:4096
    ds_read_b64_tr_b16 v[72:73], v49 offset:2048
    ds_read_b64_tr_b16 v[74:75], v49 offset:2560
    ds_read_b128 v[80:83], v46 offset:0
    ds_read_b128 v[84:87], v46 offset:4096
    s_waitcnt lgkmcnt(12)
    v_mfma_f32_32x32x16_bf16 v[120:135], v[88:91], v[96:99], v[120:135]
    v_mfma_f32_32x32x16_bf16 v[136:151], v[88:91], v[100:103], v[136:151]
    s_waitcnt lgkmcnt(8)
    v_mfma_f32_32x32x16_bf16 v[120:135], v[104:107], v[112:115], v[120:135]
    v_mfma_f32_32x32x16_bf16 v[136:151], v[104:107], v[116:119], v[136:151]
    ds_read_b64_tr_b16 v[88:89], v49 offset:4096
    ds_read_b64_tr_b16 v[90:91], v49 offset:4608
    ds_read_b128 v[96:99], v47 offset:0
    ds_read_b128 v[100:103], v47 offset:4096
    ds_read_b64_tr_b16 v[104:105], v49 offset:6144
    ds_read_b64_tr_b16 v[106:107], v49 offset:6656
    ds_read_b128 v[112:115], v48 offset:0
    ds_read_b128 v[116:119], v48 offset:4096
    s_waitcnt lgkmcnt(12)
    v_mfma_f32_32x32x16_bf16 v[120:135], v[56:59], v[64:67], v[120:135]
    v_mfma_f32_32x32x16_bf16 v[136:151], v[56:59], v[68:71], v[136:151]
    s_waitcnt lgkmcnt(8)
    v_mfma_f32_32x32x16_bf16 v[120:135], v[72:75], v[80:83], v[120:135]
    v_mfma_f32_32x32x16_bf16 v[136:151], v[72:75], v[84:87], v[136:151]
    s_waitcnt vmcnt(18)
    s_barrier
    s_add_u32 m0, s19, 98304
    s_nop 0
    buffer_load_dwordx4 v6, s[4:7], s16 offen offset:0 lds
    buffer_load_dwordx4 v7, s[4:7], s16 offen offset:1024 lds
    buffer_load_dwordx4 v8, s[4:7], s16 offen offset:2048 lds
    buffer_load_dwordx4 v9, s[4:7], s16 offen offset:3072 lds
    s_add_u32 m0, s20, 98304
    s_add_u32 s16, s16, 128
    buffer_load_dwordx4 v52, s[44:47], s17 offen offset:0 lds
    buffer_load_dwordx4 v53, s[44:47], s17 offen offset:1024 lds
    s_add_u32 s17, s17, 81920
    ds_read_b64_tr_b16 v[56:57], v24 offset:0
    ds_read_b64_tr_b16 v[58:59], v24 offset:512
    ds_read_b128 v[64:67], v20 offset:0
    ds_read_b128 v[68:71], v20 offset:4096
    ds_read_b64_tr_b16 v[72:73], v24 offset:2048
    ds_read_b64_tr_b16 v[74:75], v24 offset:2560
    ds_read_b128 v[80:83], v21 offset:0
    ds_read_b128 v[84:87], v21 offset:4096
    s_waitcnt lgkmcnt(12)
    v_mfma_f32_32x32x16_bf16 v[120:135], v[88:91], v[96:99], v[120:135]
    v_mfma_f32_32x32x16_bf16 v[136:151], v[88:91], v[100:103], v[136:151]
    s_waitcnt lgkmcnt(8)
    v_mfma_f32_32x32x16_bf16 v[120:135], v[104:107], v[112:115], v[120:135]
    v_mfma_f32_32x32x16_bf16 v[136:151], v[104:107], v[116:119], v[136:151]
    ds_read_b64_tr_b16 v[88:89], v24 offset:4096
    ds_read_b64_tr_b16 v[90:91], v24 offset:4608
    ds_read_b128 v[96:99], v22 offset:0
    ds_read_b128 v[100:103], v22 offset:4096
    ds_read_b64_tr_b16 v[104:105], v24 offset:6144
    ds_read_b64_tr_b16 v[106:107], v24 offset:6656
    ds_read_b128 v[112:115], v23 offset:0
    ds_read_b128 v[116:119], v23 offset:4096
    s_waitcnt lgkmcnt(12)
    v_mfma_f32_32x32x16_bf16 v[120:135], v[56:59], v[64:67], v[120:135]
    v_mfma_f32_32x32x16_bf16 v[136:151], v[56:59], v[68:71], v[136:151]
    s_waitcnt lgkmcnt(8)
    v_mfma_f32_32x32x16_bf16 v[120:135], v[72:75], v[80:83], v[120:135]
    v_mfma_f32_32x32x16_bf16 v[136:151], v[72:75], v[84:87], v[136:151]
    s_waitcnt vmcnt(18)
    s_barrier
    s_add_u32 m0, s19, 122880
    s_nop 0
    buffer_load_dwordx4 v6, s[4:7], s16 offen offset:0 lds
    buffer_load_dwordx4 v7, s[4:7], s16 offen offset:1024 lds
    buffer_load_dwordx4 v8, s[4:7], s16 offen offset:2048 lds
    buffer_load_dwordx4 v9, s[4:7], s16 offen offset:3072 lds
    s_add_u32 m0, s20, 122880
    s_add_u32 s16, s16, 128
    buffer_load_dwordx4 v52, s[44:47], s17 offen offset:0 lds
    buffer_load_dwordx4 v53, s[44:47], s17 offen offset:1024 lds
    s_add_u32 s17, s17, 81920
    ds_read_b64_tr_b16 v[56:57], v29 offset:0
    ds_read_b64_tr_b16 v[58:59], v29 offset:512
    ds_read_b128 v[64:67], v25 offset:0
    ds_read_b128 v[68:71], v25 offset:4096
    ds_read_b64_tr_b16 v[72:73], v29 offset:2048
    ds_read_b64_tr_b16 v[74:75], v29 offset:2560
    ds_read_b128 v[80:83], v26 offset:0
    ds_read_b128 v[84:87], v26 offset:4096
    s_waitcnt lgkmcnt(12)
    v_mfma_f32_32x32x16_bf16 v[120:135], v[88:91], v[96:99], v[120:135]
    v_mfma_f32_32x32x16_bf16 v[136:151], v[88:91], v[100:103], v[136:151]
    s_waitcnt lgkmcnt(8)
    v_mfma_f32_32x32x16_bf16 v[120:135], v[104:107], v[112:115], v[120:135]
    v_mfma_f32_32x32x16_bf16 v[136:151], v[104:107], v[116:119], v[136:151]
    ds_read_b64_tr_b16 v[88:89], v29 offset:4096
    ds_read_b64_tr_b16 v[90:91], v29 offset:4608
    ds_read_b128 v[96:99], v27 offset:0
    ds_read_b128 v[100:103], v27 offset:4096
    ds_read_b64_tr_b16 v[104:105], v29 offset:6144
    ds_read_b64_tr_b16 v[106:107], v29 offset:6656
    ds_read_b128 v[112:115], v28 offset:0
    ds_read_b128 v[116:119], v28 offset:4096
    s_waitcnt lgkmcnt(12)
    v_mfma_f32_32x32x16_bf16 v[120:135], v[56:59], v[64:67], v[120:135]
    v_mfma_f32_32x32x16_bf16 v[136:151], v[56:59], v[68:71], v[136:151]
    s_waitcnt lgkmcnt(8)
    v_mfma_f32_32x32x16_bf16 v[120:135], v[72:75], v[80:83], v[120:135]
    v_mfma_f32_32x32x16_bf16 v[136:151], v[72:75], v[84:87], v[136:151]
    s_waitcnt vmcnt(18)
    s_barrier
    s_add_u32 m0, s19, 0
    s_nop 0
    buffer_load_dwordx4 v6, s[4:7], s16 offen offset:0 lds
    buffer_load_dwordx4 v7, s[4:7], s16 offen offset:1024 lds
    buffer_load_dwordx4 v8, s[4:7], s16 offen offset:2048 lds
    buffer_load_dwordx4 v9, s[4:7], s16 offen offset:3072 lds
    s_add_u32 m0, s20, 0
    s_add_u32 s16, s16, 128
    buffer_load_dwordx4 v52, s[44:47], s17 offen offset:0 lds
    buffer_load_dwordx4 v53, s[44:47], s17 offen offset:1024 lds
    s_add_u32 s17, s17, 81920
    ds_read_b64_tr_b16 v[56:57], v34 offset:0
    ds_read_b64_tr_b16 v[58:59], v34 offset:512
    ds_read_b128 v[64:67], v30 offset:0
    ds_read_b128 v[68:71], v30 offset:4096
    ds_read_b64_tr_b16 v[72:73], v34 offset:2048
    ds_read_b64_tr_b16 v[74:75], v34 offset:2560
    ds_read_b128 v[80:83], v31 offset:0
    ds_read_b128 v[84:87], v31 offset:4096
    s_waitcnt lgkmcnt(12)
    v_mfma_f32_32x32x16_bf16 v[120:135], v[88:91], v[96:99], v[120:135]
    v_mfma_f32_32x32x16_bf16 v[136:151], v[88:91], v[100:103], v[136:151]
    s_waitcnt lgkmcnt(8)
    v_mfma_f32_32x32x16_bf16 v[120:135], v[104:107], v[112:115], v[120:135]
    v_mfma_f32_32x32x16_bf16 v[136:151], v[104:107], v[116:119], v[136:151]
    s_sub_u32 s39, s39, 1
    s_cmp_lg_u32 s39, 0
    s_cbranch_scc1 gemm2_kernel_loop
    ds_read_b64_tr_b16 v[88:89], v34 offset:4096
    ds_read_b64_tr_b16 v[90:91], v34 offset:4608
    ds_read_b128 v[96:99], v32 offset:0
    ds_read_b128 v[100:103], v32 offset:4096
    ds_read_b64_tr_b16 v[104:105], v34 offset:6144
    ds_read_b64_tr_b16 v[106:107], v34 offset:6656
    ds_read_b128 v[112:115], v33 offset:0
    ds_read_b128 v[116:119], v33 offset:4096
    s_waitcnt lgkmcnt(12)
    v_mfma_f32_32x32x16_bf16 v[120:135], v[56:59], v[64:67], v[120:135]
    v_mfma_f32_32x32x16_bf16 v[136:151], v[56:59], v[68:71], v[136:151]
    s_waitcnt lgkmcnt(8)
    v_mfma_f32_32x32x16_bf16 v[120:135], v[72:75], v[80:83], v[120:135]
    v_mfma_f32_32x32x16_bf16 v[136:151], v[72:75], v[84:87], v[136:151]
    s_waitcnt lgkmcnt(4)
    v_mfma_f32_32x32x16_bf16 v[120:135], v[88:91], v[96:99], v[120:135]
    v_mfma_f32_32x32x16_bf16 v[136:151], v[88:91], v[100:103], v[136:151]
    s_waitcnt lgkmcnt(0)
    v_mfma_f32_32x32x16_bf16 v[120:135], v[104:107], v[112:115], v[120:135]
    v_mfma_f32_32x32x16_bf16 v[136:151], v[104:107], v[116:119], v[136:151]
    s_mov_b32 s25, 0xffff0000
    s_mov_b32 s29, 0
    s_mov_b32 s30, 40960
    s_nop 7
    s_nop 1
    s_waitcnt vmcnt(0)
    v_cvt_pk_bf16_f32 v22, v120, v121
    v_lshlrev_b32 v24, 16, v22
    v_and_b32 v25, s25, v22
    v_lshlrev_b32 v26, 16, v184
    v_lshlrev_b32 v27, 16, v185
    v_add_f32 v24, v24, v26
    v_add_f32 v25, v25, v27
    v_cvt_pk_bf16_f32 v56, v24, v25
    v_cvt_pk_bf16_f32 v22, v122, v123
    v_lshlrev_b32 v24, 16, v22
    v_and_b32 v25, s25, v22
    v_lshlrev_b32 v26, 16, v186
    v_lshlrev_b32 v27, 16, v187
    v_add_f32 v24, v24, v26
    v_add_f32 v25, v25, v27
    v_cvt_pk_bf16_f32 v57, v24, v25
    buffer_store_dwordx2 v[56:57], v17, s[8:11], s29 offen offset:0
    v_cvt_pk_bf16_f32 v22, v124, v125
    v_lshlrev_b32 v24, 16, v22
    v_and_b32 v25, s25, v22
    v_lshlrev_b32 v26, 16, v188
    v_lshlrev_b32 v27, 16, v189
    v_add_f32 v24, v24, v26
    v_add_f32 v25, v25, v27
    v_cvt_pk_bf16_f32 v58, v24, v25
    v_cvt_pk_bf16_f32 v22, v126, v127
    v_lshlrev_b32 v24, 16, v22
    v_and_b32 v25, s25, v22
    v_lshlrev_b32 v26, 16, v190
    v_lshlrev_b32 v27, 16, v191
    v_add_f32 v24, v24, v26
    v_add_f32 v25, v25, v27
    v_cvt_pk_bf16_f32 v59, v24, v25
    buffer_store_dwordx2 v[58:59], v17, s[8:11], s29 offen offset:16
    v_cvt_pk_bf16_f32 v22, v128, v129
    v_lshlrev_b32 v24, 16, v22
    v_and_b32 v25, s25, v22
    v_lshlrev_b32 v26, 16, v192
    v_lshlrev_b32 v27, 16, v193
    v_add_f32 v24, v24, v26
    v_add_f32 v25, v25, v27
    v_cvt_pk_bf16_f32 v60, v24, v25
    v_cvt_pk_bf16_f32 v22, v130, v131
    v_lshlrev_b32 v24, 16, v22
    v_and_b32 v25, s25, v22
    v_lshlrev_b32 v26, 16, v194
    v_lshlrev_b32 v27, 16, v195
    v_add_f32 v24, v24, v26
    v_add_f32 v25, v25, v27
    v_cvt_pk_bf16_f32 v61, v24, v25
    buffer_store_dwordx2 v[60:61], v17, s[8:11], s29 offen offset:32
    v_cvt_pk_bf16_f32 v22, v132, v133
    v_lshlrev_b32 v24, 16, v22
    v_and_b32 v25, s25, v22
    v_lshlrev_b32 v26, 16, v196
    v_lshlrev_b32 v27, 16, v197
    v_add_f32 v24, v24, v26
    v_add_f32 v25, v25, v27
    v_cvt_pk_bf16_f32 v62, v24, v25
    v_cvt_pk_bf16_f32 v22, v134, v135
    v_lshlrev_b32 v24, 16, v22
    v_and_b32 v25, s25, v22
    v_lshlrev_b32 v26, 16, v198
    v_lshlrev_b32 v27, 16, v199
    v_add_f32 v24, v24, v26
    v_add_f32 v25, v25, v27
    v_cvt_pk_bf16_f32 v63, v24, v25
    buffer_store_dwordx2 v[62:63], v17, s[8:11], s29 offen offset:48
    v_cvt_pk_bf16_f32 v22, v136, v137
    v_lshlrev_b32 v24, 16, v22
    v_and_b32 v25, s25, v22
    v_lshlrev_b32 v26, 16, v200
    v_lshlrev_b32 v27, 16, v201
    v_add_f32 v24, v24, v26
    v_add_f32 v25, v25, v27
    v_cvt_pk_bf16_f32 v64, v24, v25
    v_cvt_pk_bf16_f32 v22, v138, v139
    v_lshlrev_b32 v24, 16, v22
    v_and_b32 v25, s25, v22
    v_lshlrev_b32 v26, 16, v202
    v_lshlrev_b32 v27, 16, v203
    v_add_f32 v24, v24, v26
    v_add_f32 v25, v25, v27
    v_cvt_pk_bf16_f32 v65, v24, v25
    buffer_store_dwordx2 v[64:65], v17, s[8:11], s30 offen offset:0
    v_cvt_pk_bf16_f32 v22, v140, v141
    v_lshlrev_b32 v24, 16, v22
    v_and_b32 v25, s25, v22
    v_lshlrev_b32 v26, 16, v204
    v_lshlrev_b32 v27, 16, v205
    v_add_f32 v24, v24, v26
    v_add_f32 v25, v25, v27
    v_cvt_pk_bf16_f32 v66, v24, v25
    v_cvt_pk_bf16_f32 v22, v142, v143
    v_lshlrev_b32 v24, 16, v22
    v_and_b32 v25, s25, v22
    v_lshlrev_b32 v26, 16, v206
    v_lshlrev_b32 v27, 16, v207
    v_add_f32 v24, v24, v26
    v_add_f32 v25, v25, v27
    v_cvt_pk_bf16_f32 v67, v24, v25
    buffer_store_dwordx2 v[66:67], v17, s[8:11], s30 offen offset:16
    v_cvt_pk_bf16_f32 v22, v144, v145
    v_lshlrev_b32 v24, 16, v22
    v_and_b32 v25, s25, v22
    v_lshlrev_b32 v26, 16, v208
    v_lshlrev_b32 v27, 16, v209
    v_add_f32 v24, v24, v26
    v_add_f32 v25, v25, v27
    v_cvt_pk_bf16_f32 v68, v24, v25
    v_cvt_pk_bf16_f32 v22, v146, v147
    v_lshlrev_b32 v24, 16, v22
    v_and_b32 v25, s25, v22
    v_lshlrev_b32 v26, 16, v210
    v_lshlrev_b32 v27, 16, v211
    v_add_f32 v24, v24, v26
    v_add_f32 v25, v25, v27
    v_cvt_pk_bf16_f32 v69, v24, v25
    buffer_store_dwordx2 v[68:69], v17, s[8:11], s30 offen offset:32
    v_cvt_pk_bf16_f32 v22, v148, v149
    v_lshlrev_b32 v24, 16, v22
    v_and_b32 v25, s25, v22
    v_lshlrev_b32 v26, 16, v212
    v_lshlrev_b32 v27, 16, v213
    v_add_f32 v24, v24, v26
    v_add_f32 v25, v25, v27
    v_cvt_pk_bf16_f32 v70, v24, v25
    v_cvt_pk_bf16_f32 v22, v150, v151
    v_lshlrev_b32 v24, 16, v22
    v_and_b32 v25, s25, v22
    v_lshlrev_b32 v26, 16, v214
    v_lshlrev_b32 v27, 16, v215
    v_add_f32 v24, v24, v26
    v_add_f32 v25, v25, v27
    v_cvt_pk_bf16_f32 v71, v24, v25
    buffer_store_dwordx2 v[70:71], v17, s[8:11], s30 offen offset:48
gemm2_kernel_end:
    s_endpgm
.section .rodata,"a"
.p2align 6
.amdhsa_kernel prep_kernel
  .amdhsa_next_free_vgpr 128
  .amdhsa_next_free_sgpr 102
  .amdhsa_accum_offset 128
  .amdhsa_group_segment_fixed_size 0
  .amdhsa_kernarg_size 112
  .amdhsa_user_sgpr_count 2
  .amdhsa_user_sgpr_kernarg_segment_ptr 1
  .amdhsa_system_sgpr_workgroup_id_x 1
.end_amdhsa_kernel
.p2align 6
.amdhsa_kernel conv_kernel
  .amdhsa_next_free_vgpr 128
  .amdhsa_next_free_sgpr 102
  .amdhsa_accum_offset 128
  .amdhsa_group_segment_fixed_size 0
  .amdhsa_kernarg_size 112
  .amdhsa_user_sgpr_count 2
  .amdhsa_user_sgpr_kernarg_segment_ptr 1
  .amdhsa_system_sgpr_workgroup_id_x 1
.end_amdhsa_kernel
.p2align 6
.amdhsa_kernel gemm1_kernel
  .amdhsa_next_free_vgpr 240
  .amdhsa_next_free_sgpr 102
  .amdhsa_accum_offset 240
  .amdhsa_group_segment_fixed_size 0
  .amdhsa_kernarg_size 112
  .amdhsa_user_sgpr_count 2
  .amdhsa_user_sgpr_kernarg_segment_ptr 1
  .amdhsa_system_sgpr_workgroup_id_x 1
.end_amdhsa_kernel
.p2align 6
.amdhsa_kernel gemm2_kernel
  .amdhsa_next_free_vgpr 256
  .amdhsa_next_free_sgpr 102
  .amdhsa_accum_offset 256
  .amdhsa_group_segment_fixed_size 0
  .amdhsa_kernarg_size 112
  .amdhsa_user_sgpr_count 2
  .amdhsa_user_sgpr_kernarg_segment_ptr 1
  .amdhsa_system_sgpr_workgroup_id_x 1
.end_amdhsa_kernel
```
